```python
import torch

def _softmax(x, axis=-1):
    return torch.softmax(x, dim=axis)
def _gelu(x):
    return torch.nn.functional.gelu(x, approximate="tanh")
def _silu(x):
    return torch.nn.functional.silu(x)
def _sigmoid(x):
    return torch.sigmoid(x)
def _layernorm(x, axis=-1, eps=1e-5):
    m = x.mean(dim=axis, keepdim=True)
    v = x.var(dim=axis, keepdim=True, unbiased=False)
    return (x - m) / torch.sqrt(v + eps)
def _scatter_add(tgt, idx, src, axis=0):
    return tgt.clone().index_add_(axis, idx, src)
def _segment_sum(src, seg, n):
    out = torch.zeros((n,) + src.shape[1:], dtype=src.dtype)
    return out.index_add_(0, seg, src)
def _pad(x, pw):
    flat = tuple(v for pair in reversed(pw) for v in pair)
    return torch.nn.functional.pad(x, flat)

kernel_name = 'gather_scatter__cheap_equivariant_egnn__graph'

def setup_inputs():

    _w = (lambda a: (lambda t: t.to(torch.bfloat16) if t.is_floating_point() else t)(torch.as_tensor(a)))
    N, deg, D, De = 10000, 64, 64, max(4, 1)
    E = N * deg
    return {
        "h": _w((lambda *s: torch.randn(*s, dtype=torch.bfloat16) * 0.2)(N, D)),
        "pos": _w((lambda *s: torch.randn(*s, dtype=torch.bfloat16) * 0.8)(N, 3)),
        "e_attr": _w((lambda *s: torch.randn(*s, dtype=torch.bfloat16) * 0.8)(E, De)),
        "src": _w((lambda lo, hi, *s: torch.randint(lo, hi, s))(0, N, E).to(torch.int64)),
        "dst": _w((lambda lo, hi, *s: torch.randint(lo, hi, s))(0, N, E).to(torch.int64)),
        "w_e": _w(0.1 * (lambda *s: torch.randn(*s, dtype=torch.bfloat16) * 0.8)(2 * D + 1 + De, D)),
        "w_x": _w(0.1 * (lambda *s: torch.randn(*s, dtype=torch.bfloat16) * 0.2)(D, 1)),
        "w_h": _w(0.1 * (lambda *s: torch.randn(*s, dtype=torch.bfloat16) * 0.2)(2 * D, D)),
    }

def reference(h, pos, e_attr, src, dst, w_e, w_x, w_h):
    N, D = h.shape[0], h.shape[1]
    diff = pos[dst] - pos[src]
    dist2 = torch.sum(diff * diff, axis=-1, keepdims=True)
    e_in = torch.concatenate([h[dst], h[src], dist2, e_attr], axis=-1)
    m_ij = _silu(e_in @ w_e)
    coord_scale = m_ij @ w_x
    pos_new = pos + _segment_sum(diff * coord_scale, dst, N)
    m_i = _segment_sum(m_ij, dst, N)
    h_new = h + _silu(torch.concatenate([h, m_i], axis=-1) @ w_h)
    return h_new, pos_new
```

```asm
; @launch kernel=sort_kernel grid=(256,1,1) block=(640,1,1) lds=69376
; @launch kernel=main_kernel grid=(250,1,1) block=(512,1,1) lds=163072
.amdgcn_target "amdgcn-amd-amdhsa--gfx950"
.text
.globl sort_kernel
.p2align 8
.type sort_kernel,@function
sort_kernel:
  s_cmp_ge_u32 s2, 256
  s_cbranch_scc1 K1_END
  s_load_dwordx16 s[4:19], s[0:1], 0
  s_load_dwordx2 s[24:25], s[0:1], 80
  v_lshrrev_b32 v1, 6, v0
  v_and_b32 v2, 63, v0
  v_readfirstlane_b32 s3, v1
  v_lshlrev_b32 v3, 4, v0
  v_lshlrev_b32 v8, 3, v0
  v_mov_b32 v4, 0
  v_mov_b32 v5, 0
  v_mov_b32 v6, 0
  v_mov_b32 v7, 0
  s_mul_i32 s20, s2, 10000
  s_mul_i32 s21, s2, 20000
  v_add_u32 v9, 5000, v8
  v_add_u32 v10, 10000, v3
  s_cmp_ge_u32 s3, 9
  s_cbranch_scc1 K1_NOZERO
  ds_write_b128 v3, v[4:7] offset:0
K1_NOZERO:
  v_cmp_gt_u32 vcc, 625, v0
  s_mov_b32 s46, 17024
  s_mov_b32 s47, 0x20000
  s_mov_b32 s50, 1280000
  s_mov_b32 s51, 0x20000
  s_mov_b64 exec, vcc
  s_mov_b64 s[22:23], vcc
  s_waitcnt lgkmcnt(0)
  s_add_u32 s12, s12, s20
  s_addc_u32 s13, s13, 0
  global_load_dwordx2 v[12:13], v8, s[12:13] nt
  global_load_dwordx2 v[14:15], v9, s[12:13] nt
  s_add_u32 s10, s10, s20
  s_addc_u32 s11, s11, 0
  s_add_u32 s8, s8, s21
  s_addc_u32 s9, s9, 0
  s_mov_b64 s[44:45], s[14:15]
  s_mov_b64 s[48:49], s[4:5]
  s_mov_b64 s[52:53], s[18:19]
  s_mov_b64 s[58:59], s[16:17]
  s_and_b32 s16, s2, 7
  s_lshl_b32 s16, s16, 5
  s_lshr_b32 s17, s2, 3
  s_add_u32 s16, s16, s17
  s_cmp_ge_u32 s2, 250
  s_cbranch_scc1 K1_WT1
K1_LD:
  s_barrier
  global_load_dwordx2 v[16:17], v8, s[10:11] nt
  global_load_dwordx2 v[18:19], v9, s[10:11] nt
  s_mov_b32 s28, s6
  s_mov_b32 s29, s7
  s_mov_b32 s30, 60000
  s_mov_b32 s31, 0x20000
  s_mov_b32 s56, 0
  s_cmp_ge_u32 s2, 250
  s_cbranch_scc1 K1_SG
  s_cmp_ge_u32 s3, 8
  s_cbranch_scc1 K1_SP
  v_lshlrev_b32 v5, 4, v2
  v_lshlrev_b32 v77, 2, v2
  v_and_b32 v77, 64, v77
  s_lshl_b32 s18, s3, 11
  s_add_u32 m0, s18, 44800
  v_xor_b32 v77, v5, v77
  buffer_load_dwordx4 v77, s[44:47], s18 offen lds
  buffer_load_dwordx4 v77, s[44:47], s18 offen offset:1024 lds
  s_mov_b32 s56, 2
  s_cmp_ge_u32 s3, 5
  s_cbranch_scc1 K1_SG
  v_lshlrev_b32 v78, 1, v2
  v_and_b32 v78, 0x70, v78
  s_lshl_b32 s18, s3, 10
  s_add_u32 m0, s18, 61184
  s_mul_i32 s19, s2, 5120
  s_add_u32 s18, s18, s19
  v_xor_b32 v78, v5, v78
  s_mov_b32 s56, 3
  buffer_load_dwordx4 v78, s[48:51], s18 offen lds
  s_branch K1_SG
K1_SP:
  s_cmp_eq_u32 s3, 8
  s_cbranch_scc1 K1_SG
  s_mul_i32 s18, s2, 240
  v_mul_u32_u24 v5, 6, v2
  s_mov_b32 exec_hi, 0xff
  buffer_load_ushort v36, v5, s[28:31], s18 offen
  buffer_load_ushort v37, v5, s[28:31], s18 offen offset:2
  buffer_load_ushort v38, v5, s[28:31], s18 offen offset:4
  s_mov_b64 exec, s[22:23]
  s_mov_b32 s56, 3
K1_SG:
  s_mov_b32 s32, s24
  s_mov_b32 s33, s25
  s_mov_b32 s34, 16777216
  s_mov_b32 s35, 0x20000
  s_mov_b64 exec, -1
  s_sub_u32 s36, s3, 2
  s_and_b32 s37, s36, 1
  s_bfe_u32 s38, s36, 0x10001
  s_lshl_b32 s39, s37, 6
  s_cmp_lt_u32 s36, 4
  s_cselect_b32 s40, 64, 0
  s_mov_b32 s43, 44800
  v_lshrrev_b32 v80, 5, v2
  v_bfe_u32 v81, v2, 2, 2
  v_lshl_add_u32 v81, v80, 3, v81
  v_add_u32 v81, s40, v81
  v_lshlrev_b32 v82, 1, v2
  v_and_b32 v82, 32, v82
  v_and_b32 v83, 3, v2
  v_lshl_or_b32 v82, v83, 3, v82
  v_lshlrev_b32 v84, 3, v2
  v_and_b32 v84, 64, v84
  v_xor_b32 v84, s39, v84
  v_lshl_add_u32 v81, v81, 7, s43
  v_add3_u32 v128, v81, v82, v84
  v_and_b32 v81, 31, v2
  s_cbranch_scc0 K1_AA
  s_lshl_b32 s41, s38, 5
  v_add_u32 v81, s41, v81
  v_lshlrev_b32 v133, 7, v81
  v_lshl_add_u32 v133, v80, 4, v133
  s_mul_i32 s42, s2, 5120
  s_add_u32 s42, s42, s39
  s_add_u32 s42, s42, 2621440
  s_branch K1_AB
K1_AA:
  v_mul_u32_u24 v133, 12, v81
  v_mov_b32 v82, 768
  v_mad_u32_u24 v133, v80, v82, v133
  v_bfe_u32 v82, v2, 3, 1
  v_lshl_add_u32 v82, v82, 2, v83
  v_min_u32 v82, 4, v82
  v_bfe_u32 v83, v2, 4, 1
  v_bfe_u32 v84, v2, 2, 1
  v_lshl_add_u32 v83, v83, 1, v84
  s_lshl_b32 s41, s38, 2
  v_add_u32 v83, s41, v83
  v_mad_u32_u24 v81, v83, 5, v82
  s_lshl_b32 s42, s2, 3
  s_add_u32 s42, s42, s41
  s_mul_i32 s42, s42, 768
  s_mul_i32 s43, s37, 384
  s_add_u32 s42, s42, s43
  s_add_u32 s42, s42, 14155776
K1_AB:
  v_and_b32 v82, 7, v81
  v_xor_b32 v82, v82, v80
  v_lshlrev_b32 v82, 4, v82
  v_lshl_add_u32 v82, v81, 7, v82
  v_add_u32 v129, 61184, v82
  v_xor_b32 v130, 32, v129
  v_xor_b32 v131, 64, v129
  v_xor_b32 v132, 96, v129
  s_mov_b64 exec, s[22:23]
  s_movk_i32 s26, -5
  v_mov_b32 v4, 1
  v_lshlrev_b32 v11, 5, v0
  s_cmp_ge_u32 s56, 3
  s_cbranch_scc1 K1_WD3
  s_cmp_ge_u32 s56, 2
  s_cbranch_scc1 K1_WD2
  s_waitcnt vmcnt(2)
K1_WD2:
  s_waitcnt vmcnt(4)
K1_WD3:
  s_waitcnt vmcnt(5)
  v_mul_u32_u24 v20, 0xcccd, v12
  v_mul_u32_u24 v21, 0xcccd, v13
  v_mul_u32_u24 v22, 0xcccd, v14
  v_mul_u32_u24 v23, 0xcccd, v15
  v_lshrrev_b32 v20, 18, v20
  v_lshrrev_b32 v21, 18, v21
  v_lshrrev_b32 v22, 18, v22
  v_lshrrev_b32 v23, 18, v23
  v_mad_i32_i24 v12, v20, s26, v12
  v_mad_i32_i24 v13, v21, s26, v13
  v_mad_i32_i24 v14, v22, s26, v14
  v_mad_i32_i24 v15, v23, s26, v15
  v_lshlrev_b32 v20, 2, v20
  v_lshlrev_b32 v21, 2, v21
  v_lshlrev_b32 v22, 2, v22
  v_lshlrev_b32 v23, 2, v23
  ds_add_rtn_u32 v24, v20, v4 offset:0
  ds_add_rtn_u32 v25, v21, v4 offset:0
  ds_add_rtn_u32 v26, v22, v4 offset:0
  ds_add_rtn_u32 v27, v23, v4 offset:0
  v_lshrrev_b32 v68, 11, v20
  v_lshrrev_b32 v69, 11, v21
  v_lshrrev_b32 v70, 11, v22
  v_lshrrev_b32 v71, 11, v23
  v_lshlrev_b32 v68, 2, v68
  v_lshlrev_b32 v69, 2, v69
  v_lshlrev_b32 v70, 2, v70
  v_lshlrev_b32 v71, 2, v71
  s_waitcnt lgkmcnt(0)
  s_barrier
  s_cmp_ge_u32 s3, 4
  s_cbranch_scc1 K1_NOPFX
  ds_read_b128 v[40:43], v11 offset:0
  ds_read_b128 v[44:47], v11 offset:16
  v_mov_b32 v5, 0x80000000
  v_lshlrev_b32 v6, 2, v2
  v_cmp_lt_u32 s[18:19], s3, v2
  v_cmp_gt_u32 vcc, 4, v2
  s_and_b64 s[18:19], s[18:19], vcc
  s_waitcnt lgkmcnt(1)
  v_add_u32 v41, v40, v41
  v_add_u32 v42, v41, v42
  v_add_u32 v43, v42, v43
  s_waitcnt lgkmcnt(0)
  v_add_u32 v44, v43, v44
  v_add_u32 v45, v44, v45
  v_add_u32 v46, v45, v46
  v_add_u32 v47, v46, v47
  v_mov_b32 v48, v47
  v_cmp_lt_u32 vcc, 32, v47
  v_lshl_or_b32 v56, v41, 6, v40
  v_lshl_or_b32 v57, v46, 6, v45
  v_add_u32_dpp v48, v48, v48 row_shr:1 row_mask:0xf bank_mask:0xf
  v_lshl_or_b32 v56, v42, 12, v56
  v_lshl_or_b32 v57, v47, 12, v57
  v_add_u32_dpp v48, v48, v48 row_shr:2 row_mask:0xf bank_mask:0xf
  v_lshl_or_b32 v56, v43, 18, v56
  v_cndmask_b32 v57, v57, v5, vcc
  v_add_u32_dpp v48, v48, v48 row_shr:4 row_mask:0xf bank_mask:0xf
  v_lshl_or_b32 v56, v44, 24, v56
  s_nop 0
  v_add_u32_dpp v48, v48, v48 row_shr:8 row_mask:0xf bank_mask:0xf
  v_cndmask_b32 v56, v56, v47, vcc
  s_nop 0
  v_add_u32_dpp v48, v48, v48 row_bcast:15 row_mask:0xa bank_mask:0xf
  s_nop 1
  v_add_u32_dpp v48, v48, v48 row_bcast:31 row_mask:0xc bank_mask:0xf
  s_nop 0
  v_readlane_b32 s20, v48, 63
  v_sub_u32 v48, v48, v47
  v_lshl_add_u32 v57, v48, 18, v57
  v_add_u32 v49, v40, v48
  v_add_u32 v50, v41, v48
  v_add_u32 v51, v42, v48
  v_add_u32 v52, v43, v48
  v_add_u32 v53, v44, v48
  v_add_u32 v54, v45, v48
  v_add_u32 v55, v46, v48
  v_mov_b32 v7, s20
  s_cbranch_vccz K1_NOFL
  v_mov_b32 v5, 0
  ds_write_b32 v5, v4 offset:8208
K1_NOFL:
  v_cmp_gt_u32 vcc, 250, v0
  s_mov_b64 exec, vcc
  ds_write_b128 v11, v[48:51] offset:0
  ds_write_b128 v11, v[52:55] offset:16
  s_mov_b64 exec, s[18:19]
  ds_add_u32 v6, v7 offset:8192
  s_mov_b64 exec, -1
K1_NOPFX:
  global_load_dwordx4 v[60:63], v3, s[8:9] nt
  global_load_dwordx4 v[64:67], v10, s[8:9] nt
  v_mov_b32 v76, 0
  s_mov_b32 s56, 0
  s_waitcnt lgkmcnt(0)
  s_barrier
  ds_read_b32 v32, v20 offset:0
  ds_read_b32 v33, v21 offset:0
  ds_read_b32 v34, v22 offset:0
  ds_read_b32 v35, v23 offset:0
  ds_read_b32 v68, v68 offset:8192
  ds_read_b32 v69, v69 offset:8192
  ds_read_b32 v70, v70 offset:8192
  ds_read_b32 v71, v71 offset:8192
  ds_read_b32 v76, v76 offset:8208
  s_cmp_ge_u32 s3, 4
  s_cbranch_scc1 K1_NOHDR
  s_lshl_b32 s20, s3, 2
  v_mov_b32 v6, s20
  ds_read_b32 v6, v6 offset:8192
  v_lshlrev_b32 v7, 11, v0
  s_lshl_b32 s20, s16, 3
  v_cmp_gt_u32 vcc, 250, v0
  s_waitcnt lgkmcnt(0)
  v_lshl_add_u32 v57, v6, 18, v57
  s_mov_b64 exec, vcc
  buffer_store_dwordx2 v[56:57], v7, s[32:35], s20 offen
  s_mov_b64 exec, -1
  s_mov_b32 s56, 1
K1_NOHDR:
  s_mul_i32 s20, s16, 20000
  s_add_u32 s20, s20, 5242880
  s_mul_i32 s21, s16, 5000
  s_add_u32 s21, s21, 1048576
  s_mov_b32 s27, 0xbfb8aa3b
  s_waitcnt lgkmcnt(0)
  v_add3_u32 v24, v24, v32, v68
  v_add3_u32 v25, v25, v33, v69
  v_add3_u32 v26, v26, v34, v70
  v_add3_u32 v27, v27, v35, v71
  v_lshlrev_b32 v28, 1, v24
  v_lshlrev_b32 v29, 1, v25
  v_lshlrev_b32 v30, 1, v26
  v_lshlrev_b32 v31, 1, v27
  v_lshlrev_b32 v32, 3, v24
  v_lshlrev_b32 v33, 3, v25
  v_lshlrev_b32 v34, 3, v26
  v_lshlrev_b32 v35, 3, v27
  v_readfirstlane_b32 s17, v76
  s_cmp_ge_u32 s56, 1
  s_cbranch_scc1 K1_WS1
  s_waitcnt vmcnt(2)
K1_WS1:
  s_waitcnt vmcnt(3)
  v_mad_u32_u24 v40, v16, 5, v12
  v_mad_u32_u24 v41, v17, 5, v13
  v_mad_u32_u24 v42, v18, 5, v14
  v_mad_u32_u24 v43, v19, 5, v15
  ds_write_b16 v28, v40 offset:9216
  ds_write_b16 v29, v41 offset:9216
  ds_write_b16 v30, v42 offset:9216
  ds_write_b16 v31, v43 offset:9216
  s_waitcnt lgkmcnt(0)
  s_barrier
  ds_read_b64 v[40:41], v8 offset:9216
  s_cmp_ge_u32 s2, 250
  s_cselect_b32 s36, 8, s36
  s_cmp_ge_u32 s36, 8
  s_cbranch_scc1 K1_NOG
  s_mov_b64 exec, -1
  ds_read_b128 v[96:99], v129
  ds_read_b64_tr_b16 v[80:81], v128 offset:0
  ds_read_b64_tr_b16 v[82:83], v128 offset:512
  ds_read_b128 v[100:103], v130
  ds_read_b64_tr_b16 v[84:85], v128 offset:2048
  ds_read_b64_tr_b16 v[86:87], v128 offset:2560
  ds_read_b128 v[104:107], v131
  ds_read_b64_tr_b16 v[88:89], v128 offset:4096
  ds_read_b64_tr_b16 v[90:91], v128 offset:4608
  ds_read_b128 v[108:111], v132
  ds_read_b64_tr_b16 v[92:93], v128 offset:6144
  ds_read_b64_tr_b16 v[94:95], v128 offset:6656
  s_mov_b64 exec, s[22:23]
  s_waitcnt lgkmcnt(12)
  buffer_store_dwordx2 v[40:41], v8, s[32:35], s21 offen
  s_mov_b64 exec, -1
  s_cmp_lt_u32 s36, 4
  s_cbranch_scc0 K1_GA
  s_waitcnt lgkmcnt(9)
  v_mfma_f32_32x32x16_bf16 v[112:127], v[80:83], v[96:99], 0
  s_waitcnt lgkmcnt(6)
  v_mfma_f32_32x32x16_bf16 v[112:127], v[84:87], v[100:103], v[112:127]
  s_waitcnt lgkmcnt(3)
  v_mfma_f32_32x32x16_bf16 v[112:127], v[88:91], v[104:107], v[112:127]
  s_waitcnt lgkmcnt(0)
  v_mfma_f32_32x32x16_bf16 v[112:127], v[92:95], v[108:111], v[112:127]
  s_branch K1_GM
K1_GA:
  s_waitcnt lgkmcnt(9)
  v_mfma_f32_32x32x16_bf16 v[112:127], v[96:99], v[80:83], 0
  s_waitcnt lgkmcnt(6)
  v_mfma_f32_32x32x16_bf16 v[112:127], v[100:103], v[84:87], v[112:127]
  s_waitcnt lgkmcnt(3)
  v_mfma_f32_32x32x16_bf16 v[112:127], v[104:107], v[88:91], v[112:127]
  s_waitcnt lgkmcnt(0)
  v_mfma_f32_32x32x16_bf16 v[112:127], v[108:111], v[92:95], v[112:127]
K1_GM:
  s_nop 7
  s_nop 3
  v_mul_f32 v112, s27, v112
  v_mul_f32 v113, s27, v113
  v_mul_f32 v114, s27, v114
  v_mul_f32 v115, s27, v115
  v_mul_f32 v116, s27, v116
  v_mul_f32 v117, s27, v117
  v_mul_f32 v118, s27, v118
  v_mul_f32 v119, s27, v119
  v_mul_f32 v120, s27, v120
  v_mul_f32 v121, s27, v121
  v_mul_f32 v122, s27, v122
  v_mul_f32 v123, s27, v123
  v_mul_f32 v124, s27, v124
  v_mul_f32 v125, s27, v125
  v_mul_f32 v126, s27, v126
  v_mul_f32 v127, s27, v127
  v_cvt_pk_bf16_f32 v112, v112, v113
  v_cvt_pk_bf16_f32 v113, v114, v115
  v_cvt_pk_bf16_f32 v114, v116, v117
  v_cvt_pk_bf16_f32 v115, v118, v119
  v_cvt_pk_bf16_f32 v116, v120, v121
  v_cvt_pk_bf16_f32 v117, v122, v123
  v_cvt_pk_bf16_f32 v118, v124, v125
  v_cvt_pk_bf16_f32 v119, v126, v127
  s_add_u32 s56, s56, 2
  s_cmp_lt_u32 s36, 4
  s_cbranch_scc0 K1_SA
  v_permlane32_swap_b32 v112, v114
  v_permlane32_swap_b32 v113, v115
  v_permlane32_swap_b32 v116, v118
  v_permlane32_swap_b32 v117, v119
  s_cmp_eq_u32 s38, 0
  s_cbranch_scc1 K1_SB
  s_mov_b32 exec_lo, 0xff
  s_mov_b32 exec_hi, 0xff
K1_SB:
  buffer_store_dwordx4 v[112:115], v133, s[32:35], s42 offen
  buffer_store_dwordx4 v[116:119], v133, s[32:35], s42 offen offset:32
  s_branch K1_SE
K1_SA:
  buffer_store_dwordx3 v[112:114], v133, s[32:35], s42 offen
  buffer_store_dwordx3 v[116:118], v133, s[32:35], s42 offen offset:1536
K1_SE:
  s_mov_b64 exec, s[22:23]
  s_branch K1_G2
K1_NOG:
  s_waitcnt lgkmcnt(0)
  buffer_store_dwordx2 v[40:41], v8, s[32:35], s21 offen
  s_cmp_ge_u32 s2, 250
  s_cbranch_scc1 K1_WT2
K1_G2:
  s_cmp_ge_u32 s56, 3
  s_cbranch_scc1 K1_WE3
  s_cmp_ge_u32 s56, 2
  s_cbranch_scc1 K1_WE2
  s_cmp_ge_u32 s56, 1
  s_cbranch_scc1 K1_WE1
  s_waitcnt vmcnt(1)
K1_WE1:
  s_waitcnt vmcnt(2)
K1_WE2:
  s_waitcnt vmcnt(3)
K1_WE3:
  s_waitcnt vmcnt(4)
  ds_write_b64 v32, v[60:61] offset:14336
  ds_write_b64 v33, v[62:63] offset:14336
  ds_write_b64 v34, v[64:65] offset:14336
  ds_write_b64 v35, v[66:67] offset:14336
  s_cmp_ge_u32 s2, 250
  s_cbranch_scc1 K1_WT3
  s_cmp_lg_u32 s3, 9
  s_cbranch_scc1 K1_NOST
  s_mov_b64 exec, -1
  v_lshlrev_b32 v36, 16, v36
  v_lshlrev_b32 v37, 16, v37
  v_lshlrev_b32 v38, 16, v38
  v_mov_b32 v39, 0
  v_lshlrev_b32 v5, 4, v2
  s_mul_i32 s18, s2, 640
  s_add_u32 s18, s18, 3901440
  s_mov_b32 exec_hi, 0xff
  buffer_store_dwordx4 v[36:39], v5, s[32:35], s18 offen
  s_mov_b64 exec, s[22:23]
K1_NOST:
  s_waitcnt lgkmcnt(0)
  s_barrier
  ds_read_b128 v[48:51], v3 offset:14336
  ds_read_b128 v[52:55], v10 offset:14336
  s_cmp_lg_u32 s17, 0
  s_waitcnt lgkmcnt(1)
  buffer_store_dwordx4 v[48:51], v3, s[32:35], s20 offen
  s_waitcnt lgkmcnt(0)
  buffer_store_dwordx4 v[52:55], v10, s[32:35], s20 offen
  s_cbranch_scc1 K1_RARE
K1_FIN:
K1_END:
  s_endpgm
K1_RARE:
  v_and_b32 v28, 28, v20
  v_and_b32 v29, 28, v21
  v_and_b32 v30, 28, v22
  v_and_b32 v31, 28, v23
  v_lshlrev_b32 v28, 15, v28
  v_lshlrev_b32 v29, 15, v29
  v_lshlrev_b32 v30, 15, v30
  v_lshlrev_b32 v31, 15, v31
  v_add3_u32 v28, v28, v12, 1
  v_add3_u32 v29, v29, v13, 1
  v_add3_u32 v30, v30, v14, 1
  v_add3_u32 v31, v31, v15, 1
  v_lshl_or_b32 v28, v32, 17, v28
  v_lshl_or_b32 v29, v33, 17, v29
  v_lshl_or_b32 v30, v34, 17, v30
  v_lshl_or_b32 v31, v35, 17, v31
  v_lshl_add_u32 v28, v16, 3, v28
  v_lshl_add_u32 v29, v17, 3, v29
  v_lshl_add_u32 v30, v18, 3, v30
  v_lshl_add_u32 v31, v19, 3, v31
  v_lshrrev_b32 v32, 1, v32
  v_lshrrev_b32 v33, 1, v33
  v_lshrrev_b32 v34, 1, v34
  v_lshrrev_b32 v35, 1, v35
  ds_write_b32 v32, v28 offset:34336
  ds_write_b32 v33, v29 offset:34336
  ds_write_b32 v34, v30 offset:34336
  ds_write_b32 v35, v31 offset:34336
  s_mul_i32 s21, s16, 10000
  s_add_u32 s21, s21, 11534336
  s_waitcnt lgkmcnt(0)
  s_barrier
  ds_read_b128 v[40:43], v3 offset:34336
  s_waitcnt lgkmcnt(0)
  buffer_store_dwordx4 v[40:43], v3, s[32:35], s21 offen
  s_branch K1_FIN
K1_WT1:
  s_sub_u32 s41, s3, 4
  s_cmp_ge_u32 s41, 4
  s_cselect_b32 s41, 64, s41
  s_sub_u32 s40, s2, 250
  s_lshl_b32 s40, s40, 2
  s_add_u32 s41, s41, s40
  s_cmp_eq_u32 s41, 18
  s_cbranch_scc0 K1_WT1A
  v_and_b32 v145, 31, v2
  v_lshlrev_b32 v145, 1, v145
  global_load_ushort v146, v145, s[58:59]
  global_load_ushort v147, v145, s[58:59] offset:64
K1_WT1A:
  s_cmp_gt_u32 s41, 16
  s_cbranch_scc1 K1_LD
  s_cmp_eq_u32 s41, 16
  s_cbranch_scc0 K1_WT1H
  v_lshlrev_b32 v144, 1, v2
  s_mov_b32 s40, 16384
  buffer_load_ushort v136, v144, s[44:47], s40 offen offset:128
  buffer_load_ushort v137, v144, s[44:47], s40 offen offset:256
  buffer_load_ushort v138, v144, s[44:47], s40 offen offset:384
  buffer_load_ushort v139, v144, s[44:47], s40 offen offset:512
  buffer_load_ushort v140, v144, s[44:47], s40 offen
  s_branch K1_LD
K1_WT1H:
  s_mov_b32 s54, 16384
  s_mov_b32 s55, 0x20000
  v_and_b32 v144, 15, v2
  v_lshrrev_b32 v145, 4, v2
  v_lshlrev_b32 v144, 3, v144
  s_and_b32 s40, s41, 3
  s_lshl_b32 s40, s40, 1
  s_lshr_b32 s43, s41, 2
  s_cmp_ge_u32 s43, 2
  s_cbranch_scc1 K1_WT1M
  v_lshl_add_u32 v144, v145, 10, v144
  s_lshl_b32 s43, s43, 12
  s_add_u32 s40, s40, s43
  buffer_load_ushort v136, v144, s[52:55], s40 offen offset:0
  buffer_load_ushort v137, v144, s[52:55], s40 offen offset:128
  buffer_load_ushort v138, v144, s[52:55], s40 offen offset:256
  buffer_load_ushort v139, v144, s[52:55], s40 offen offset:384
  buffer_load_ushort v140, v144, s[52:55], s40 offen offset:512
  buffer_load_ushort v141, v144, s[52:55], s40 offen offset:640
  buffer_load_ushort v142, v144, s[52:55], s40 offen offset:768
  buffer_load_ushort v143, v144, s[52:55], s40 offen offset:896
  s_branch K1_LD
K1_WT1M:
  v_lshl_add_u32 v144, v145, 9, v144
  s_sub_u32 s43, s43, 2
  s_lshl_b32 s43, s43, 11
  s_add_u32 s40, s40, s43
  s_add_u32 s40, s40, 8192
  s_add_u32 s43, s40, 4096
  buffer_load_ushort v136, v144, s[52:55], s40 offen offset:0
  buffer_load_ushort v137, v144, s[52:55], s43 offen offset:0
  buffer_load_ushort v138, v144, s[52:55], s40 offen offset:128
  buffer_load_ushort v139, v144, s[52:55], s43 offen offset:128
  buffer_load_ushort v140, v144, s[52:55], s40 offen offset:256
  buffer_load_ushort v141, v144, s[52:55], s43 offen offset:256
  buffer_load_ushort v142, v144, s[52:55], s40 offen offset:384
  buffer_load_ushort v143, v144, s[52:55], s43 offen offset:384
  s_branch K1_LD
K1_WT2:
  s_sub_u32 s41, s3, 4
  s_cmp_ge_u32 s41, 4
  s_cselect_b32 s41, 64, s41
  s_sub_u32 s40, s2, 250
  s_lshl_b32 s40, s40, 2
  s_add_u32 s41, s41, s40
  v_lshlrev_b32 v128, 4, v2
  s_cmp_lt_u32 s41, 16
  s_cbranch_scc0 K1_WT2X
  v_lshl_or_b32 v112, v137, 16, v136
  v_lshl_or_b32 v113, v139, 16, v138
  v_lshl_or_b32 v114, v141, 16, v140
  v_lshl_or_b32 v115, v143, 16, v142
  s_lshl_b32 s40, s41, 10
  s_add_u32 s40, s40, 10756096
  s_branch K1_G2
K1_WT2X:
  s_mov_b32 s40, 10747904
  s_cmp_eq_u32 s41, 16
  s_cbranch_scc0 K1_WT2I
  v_lshlrev_b32 v136, 16, v136
  v_lshlrev_b32 v137, 16, v137
  v_lshlrev_b32 v138, 16, v138
  v_lshlrev_b32 v139, 16, v139
  v_lshlrev_b32 v140, 16, v140
  v_mul_f32 v136, s27, v136
  v_mul_f32 v137, s27, v137
  v_mul_f32 v138, s27, v138
  v_mul_f32 v139, s27, v139
  v_mul_f32 v140, s27, v140
  v_cvt_pk_bf16_f32 v112, v136, v137
  v_cvt_pk_bf16_f32 v113, v138, v139
  v_cvt_pk_bf16_f32 v141, v140, v140
  v_and_b32 v141, 0xffff0000, v141
  v_sub_f32 v142, v140, v141
  v_cvt_pk_bf16_f32 v114, v141, v142
  v_mul_u32_u24 v128, 12, v2
  s_branch K1_G2
K1_WT2I:
  s_cmp_eq_u32 s41, 17
  s_cbranch_scc0 K1_WT2C
  v_bfe_u32 v136, v2, 1, 1
  v_and_b32 v137, 1, v2
  v_lshlrev_b32 v136, 2, v136
  v_lshl_add_u32 v136, v137, 1, v136
  v_bfe_u32 v137, v2, 3, 1
  v_add_u32 v136, v136, v137
  v_bfe_u32 v137, v2, 2, 1
  v_lshlrev_b32 v137, 4, v137
  v_mov_b32 v138, 0x3f80
  v_lshlrev_b32 v137, v137, v138
  v_lshrrev_b32 v138, 5, v2
  v_bfe_u32 v139, v2, 4, 1
  v_cmp_eq_u32 vcc, v138, v139
  s_nop 1
  v_cndmask_b32 v137, 0, v137, vcc
  v_cmp_eq_u32 vcc, 0, v136
  s_nop 1
  v_cndmask_b32 v112, 0, v137, vcc
  v_cmp_eq_u32 vcc, 1, v136
  s_nop 1
  v_cndmask_b32 v113, 0, v137, vcc
  v_cmp_eq_u32 vcc, 2, v136
  s_nop 1
  v_cndmask_b32 v114, 0, v137, vcc
  v_cmp_eq_u32 vcc, 3, v136
  s_nop 1
  v_cndmask_b32 v115, 0, v137, vcc
  v_cmp_eq_u32 vcc, 4, v136
  s_nop 1
  v_cndmask_b32 v116, 0, v137, vcc
  v_cmp_eq_u32 vcc, 5, v136
  s_nop 1
  v_cndmask_b32 v117, 0, v137, vcc
  v_cmp_eq_u32 vcc, 6, v136
  s_nop 1
  v_cndmask_b32 v118, 0, v137, vcc
  v_cmp_eq_u32 vcc, 7, v136
  s_nop 1
  v_cndmask_b32 v119, 0, v137, vcc
  v_lshrrev_b32 v136, 2, v2
  v_and_b32 v137, 3, v2
  v_lshlrev_b32 v137, 1, v137
  v_sub_u32 v136, v136, v137
  v_mov_b32 v138, 0x3f800000
  v_mov_b32 v139, 0x3f80
  v_cmp_eq_u32 vcc, 1, v136
  s_nop 1
  v_cndmask_b32 v137, 0, v139, vcc
  v_cmp_eq_u32 vcc, 2, v136
  s_nop 1
  v_cndmask_b32 v137, v137, v138, vcc
  v_cmp_gt_u32 vcc, 24, v2
  s_nop 1
  v_cndmask_b32 v137, 0, v137, vcc
  s_branch K1_G2
K1_WT2C:
  s_cmp_eq_u32 s41, 18
  s_cbranch_scc0 K1_G2
  s_add_u32 s40, s40, 4096
  v_and_b32 v140, 31, v2
  v_lshrrev_b32 v141, 5, v2
  v_and_b32 v136, 7, v2
  v_bfe_u32 v137, v2, 4, 1
  v_lshlrev_b32 v137, 2, v137
  v_xor_b32 v136, v136, v137
  v_lshlrev_b32 v112, 4, v136
  v_bfe_u32 v136, v2, 2, 2
  v_lshl_add_u32 v136, v141, 2, v136
  v_lshlrev_b32 v136, 7, v136
  v_lshlrev_b32 v137, 1, v2
  v_and_b32 v137, 32, v137
  v_and_b32 v138, 3, v2
  v_lshl_or_b32 v137, v138, 3, v137
  v_lshlrev_b32 v138, 3, v2
  v_and_b32 v138, 64, v138
  v_add3_u32 v136, v136, v137, v138
  v_add_u32 v113, 4096, v136
  v_xor_b32 v114, 64, v113
  v_lshrrev_b32 v136, 1, v140
  v_mul_u32_u24 v136, 96, v136
  v_and_b32 v137, 1, v140
  v_lshl_add_u32 v136, v137, 3, v136
  v_mul_u32_u24 v137, 1536, v141
  v_add_u32 v136, 12288, v136
  v_add_u32 v115, v136, v137
  v_bfe_u32 v136, v2, 3, 1
  v_lshl_add_u32 v136, v141, 1, v136
  v_mul_u32_u24 v136, 96, v136
  v_bfe_u32 v137, v2, 4, 1
  v_and_b32 v138, 3, v2
  v_lshl_add_u32 v137, v137, 2, v138
  v_lshl_add_u32 v136, v137, 4, v136
  v_bfe_u32 v137, v2, 2, 1
  v_lshl_add_u32 v136, v137, 3, v136
  v_add_u32 v116, 12288, v136
  v_lshlrev_b32 v136, 2, v140
  v_lshl_add_u32 v117, v141, 7, v136
  v_and_b32 v142, 15, v2
  v_lshrrev_b32 v143, 4, v2
  v_and_b32 v136, 1, v2
  v_lshrrev_b32 v144, 2, v142
  v_lshl_or_b32 v144, v136, 2, v144
  v_lshlrev_b32 v136, 7, v144
  v_lshl_add_u32 v118, v143, 4, v136
  v_lshl_or_b32 v123, v147, 16, v146
  v_bfe_u32 v136, v2, 2, 1
  v_bfe_u32 v137, v2, 3, 1
  v_lshl_add_u32 v136, v136, 1, v137
  v_bfe_u32 v137, v2, 4, 1
  v_lshl_add_u32 v138, v137, 2, v136
  v_and_b32 v137, 3, v2
  v_cmp_eq_u32 vcc, 0, v137
  s_nop 1
  v_cndmask_b32 v138, 8, v138, vcc
  v_mul_u32_u24 v136, 11, v138
  v_lshrrev_b32 v136, 5, v136
  v_mul_u32_u24 v137, 3, v136
  v_sub_u32 v137, v138, v137
  v_lshl_add_u32 v136, v136, 1, v141
  v_lshlrev_b32 v138, 4, v136
  v_lshl_add_u32 v119, v137, 2, v138
  v_mul_u32_u24 v136, 6, v136
  v_lshl_add_u32 v120, v137, 1, v136
  v_lshlrev_b32 v122, 3, v142
  v_lshl_add_u32 v121, v143, 7, v122
  s_branch K1_G2
K1_WT3:
  s_cmp_lt_u32 s41, 16
  s_cbranch_scc0 K1_WT3X
  buffer_store_dwordx4 v[112:115], v128, s[32:35], s40 offen
  s_branch K1_NOST
K1_WT3X:
  s_cmp_eq_u32 s41, 16
  s_cbranch_scc0 K1_WT3I
  buffer_store_dwordx3 v[112:114], v128, s[32:35], s40 offen offset:0
  s_branch K1_NOST
K1_WT3I:
  s_cmp_eq_u32 s41, 17
  s_cbranch_scc0 K1_WT3C
  buffer_store_dwordx4 v[112:115], v128, s[32:35], s40 offen offset:1024
  buffer_store_dwordx4 v[116:119], v128, s[32:35], s40 offen offset:2048
  v_lshlrev_b32 v136, 2, v2
  s_mov_b32 exec_hi, 0xf
  buffer_store_dword v137, v136, s[32:35], s40 offen offset:768
  s_mov_b32 exec_hi, -1
  s_branch K1_NOST
K1_WT3C:
  s_cmp_eq_u32 s41, 18
  s_cbranch_scc0 K1_NOST
  buffer_store_dwordx4 v[112:115], v128, s[32:35], s40 offen offset:0
  buffer_store_dwordx4 v[116:119], v128, s[32:35], s40 offen offset:1024
  buffer_store_dwordx4 v[120:123], v128, s[32:35], s40 offen offset:2048
  s_branch K1_NOST
.globl main_kernel
.p2align 8
.type main_kernel,@function
main_kernel:
  s_cmp_ge_u32 s2, 250
  s_cbranch_scc1 K2_END
  s_load_dwordx2 s[32:33], s[0:1], 80
  s_load_dwordx2 s[44:45], s[0:1], 0
  s_load_dwordx2 s[48:49], s[0:1], 64
  s_setprio 3
  v_lshrrev_b32 v1, 6, v0
  v_and_b32 v252, 63, v0
  v_readfirstlane_b32 s13, v1
  s_and_b32 s6, s2, 7
  s_lshr_b32 s7, s2, 3
  s_mul_i32 s8, s6, 31
  s_min_u32 s6, s6, 2
  s_add_u32 s6, s6, s8
  s_add_u32 s6, s6, s7
  s_lshl_b32 s19, s6, 11
  v_lshrrev_b32 v29, 2, v252
  v_lshlrev_b32 v21, 5, v252
  v_lshlrev_b32 v28, 3, v29
  v_lshlrev_b32 v20, 4, v252
  s_mov_b32 s34, 16777216
  s_mov_b32 s35, 0x20000
  s_lshl_b32 s63, s13, 8
  s_add_u32 s7, s19, s63
  s_lshl_b32 s12, s13, 11
  s_add_u32 m0, s12, 18432
  s_add_u32 s8, s12, 10756096
  v_mov_b32 v136, 0
  v_mov_b32 v137, 0
  v_mov_b32 v138, 0
  v_mov_b32 v139, 0
  s_lshl_b32 s26, s6, 3
  s_add_u32 s26, s26, s13
  s_mul_i32 s27, s13, 16032
  s_add_u32 s27, s27, 34816
  s_waitcnt lgkmcnt(0)
  buffer_load_dword v30, v28, s[32:35], s7 offen offset:4
  buffer_load_dword v31, v28, s[32:35], s7 offen offset:132
  buffer_load_dwordx4 v[0:3], v21, s[32:35], s19 offen offset:0
  buffer_load_dwordx4 v[4:7], v21, s[32:35], s19 offen offset:16
  buffer_load_dwordx4 v20, s[32:35], s8 offen lds
  buffer_load_dwordx4 v20, s[32:35], s8 offen offset:1024 lds
  v_mfma_f32_32x32x16_bf16 v[64:79], v[136:139], v[136:139], 0
  v_mfma_f32_32x32x16_bf16 v[80:95], v[136:139], v[136:139], 0
  v_mfma_f32_32x32x16_bf16 v[208:223], v[136:139], v[136:139], 0
  v_mfma_f32_32x32x16_bf16 v[192:207], v[136:139], v[136:139], 0
  v_mul_u32_u24 v29, 5000, v29
  v_and_b32 v28, 3, v252
  v_lshl_add_u32 v28, v28, 4, v29
  v_add_u32 v29, 78976, v28
  s_add_u32 m0, s12, 2048
  s_mul_i32 s12, s13, 160000
  s_add_u32 s12, s12, 1048576
  s_add_u32 s0, s27, 4096
  s_add_u32 s1, s27, 8192
  s_mov_b32 s29, 0
  s_mov_b32 s24, 1
  s_mul_i32 s62, s13, 6
  s_cmp_ge_u32 s13, 6
  s_cselect_b32 s60, 4, 6
  s_sub_u32 s62, s62, s60
  s_cmp_eq_u32 s13, 5
  s_cselect_b32 s10, 8, 6
  s_cmp_eq_u32 s13, 0
  s_cselect_b32 s62, 0, s62
  s_cselect_b32 s10, 0, s10
  s_cselect_b32 s9, 0, 63
  v_lshlrev_b32 v126, 5, v252
  v_add_u32 v125, s0, v20
  v_lshlrev_b32 v112, 8, v252
  v_add_u32 v112, 2048, v112
  v_mul_u32_u24 v116, 80000, v252
  v_add_u32 v120, s1, v126
  ds_write_b128 v125, v[136:139]
  ds_write_b128 v125, v[136:139] offset:1024
  v_add_u32 v113, 64, v112
  v_add_u32 v117, 20000, v116
  v_add_u32 v121, 8, v120
  v_add_u32 v114, 128, v112
  v_add_u32 v118, 40000, v116
  v_add_u32 v122, 16, v120
  v_add_u32 v115, 192, v112
  v_add_u32 v119, 60000, v116
  v_add_u32 v123, 24, v120
  s_mov_b64 s[64:65], 0
  s_mov_b64 s[66:67], 0
  s_mov_b64 s[68:69], 0
  s_mov_b64 s[70:71], 0
  s_mov_b32 s38, 10747904
  s_mov_b32 s39, 10752000
  s_mov_b32 s17, 3901440
  s_mov_b32 s46, 1280000
  s_mov_b32 s47, 0x20000
  v_and_b32 v26, 3, v252
  v_lshlrev_b32 v26, 3, v26
  s_waitcnt vmcnt(4)
  v_bfe_u32 v24, v30, 12, 6
  v_bfe_u32 v30, v30, 18, 12
  v_bfe_u32 v25, v31, 12, 6
  v_cmp_gt_u32 vcc, v24, v26
  v_lshl_add_u32 v30, v30, 1, v28
  v_bfe_u32 v31, v31, 18, 12
  s_or_b64 exec, vcc, 1
  buffer_load_dwordx4 v30, s[32:35], s12 offen lds
  s_mov_b64 exec, -1
  v_cmp_gt_u32 vcc, v25, v26
  v_lshl_add_u32 v31, v31, 1, v29
  s_or_b64 exec, vcc, 1
  buffer_load_dwordx4 v31, s[32:35], s12 offen offset:1024 lds
  s_mov_b64 exec, -1
  s_waitcnt vmcnt(4)
K2_LIST1:
  s_movk_i32 s61, 448
  s_cmp_ge_u32 s62, 32
  s_cbranch_scc1 K2_SHI
  v_alignbit_b32 v8, v1, v0, s62
  v_alignbit_b32 v10, v3, v2, s62
  v_alignbit_b32 v12, v5, v4, s62
  v_alignbit_b32 v14, v7, v6, s62
K2_SHR:
  v_or3_b32 v124, v1, v3, v5
  v_and_b32 v16, s9, v8
  v_bfe_u32 v24, v8, s10, 6
  v_and_b32 v17, s9, v10
  v_bfe_u32 v25, v10, s10, 6
  v_and_b32 v18, s9, v12
  v_bfe_u32 v26, v12, s10, 6
  v_and_b32 v19, s9, v14
  v_bfe_u32 v27, v14, s10, 6
  v_or_b32 v124, v124, v7
  v_sub_u32 v24, v24, v16
  v_sub_u32 v25, v25, v17
  v_sub_u32 v26, v26, v18
  v_sub_u32 v27, v27, v19
  v_cmp_gt_i32 vcc, 0, v124
  s_cbranch_vccnz K2_FLAG
K2_FLAGRET:
  v_add_u32 v28, v24, v25
  v_add_u32 v29, v28, v26
  v_add_u32 v31, v29, v27
  v_add_u32 v30, s29, v31
  v_bfe_u32 v8, v1, 18, 12
  v_bfe_u32 v9, v3, 18, 12
  v_add_u32_dpp v31, v31, v31 row_shr:1 row_mask:0xf bank_mask:0xf
  v_bfe_u32 v10, v5, 18, 12
  v_bfe_u32 v11, v7, 18, 12
  v_add_u32_dpp v31, v31, v31 row_shr:2 row_mask:0xf bank_mask:0xf
  v_add_u32 v8, v8, v16
  v_add_u32 v9, v9, v17
  v_add_u32_dpp v31, v31, v31 row_shr:4 row_mask:0xf bank_mask:0xf
  v_add_u32 v10, v10, v18
  v_add_u32 v11, v11, v19
  v_add_u32_dpp v31, v31, v31 row_shr:8 row_mask:0xf bank_mask:0xf
  v_lshl_add_u32 v112, v16, 1, v112
  v_lshl_add_u32 v113, v17, 1, v113
  v_add_u32_dpp v31, v31, v31 row_bcast:15 row_mask:0xa bank_mask:0xf
  v_lshl_add_u32 v114, v18, 1, v114
  v_lshl_add_u32 v115, v19, 1, v115
  v_lshl_add_u32 v116, v8, 3, v116
  v_add_u32_dpp v31, v31, v31 row_bcast:31 row_mask:0xc bank_mask:0xf
  v_lshl_add_u32 v117, v9, 3, v117
  v_lshl_add_u32 v118, v10, 3, v118
  v_lshl_add_u32 v119, v11, 3, v119
  v_sub_u32 v172, v31, v30
  v_readlane_b32 s28, v31, 63
  v_add_u32 v173, v172, v24
  v_add_u32 v174, v172, v28
  v_add_u32 v175, v172, v29
  v_med3_i32 v168, v172, 0, s61
  v_med3_i32 v169, v173, 0, s61
  v_med3_i32 v170, v174, 0, s61
  v_med3_i32 v171, v175, 0, s61
  v_lshl_add_u32 v168, v168, 2, s0
  v_lshl_add_u32 v169, v169, 2, s0
  v_lshl_add_u32 v170, v170, 2, s0
  v_lshl_add_u32 v171, v171, 2, s0
  ds_max_u32 v168, v120
  ds_max_u32 v169, v121
  ds_max_u32 v170, v122
  ds_max_u32 v171, v123
  v_mad_i32_i24 v160, v172, -2, v112
  v_mad_i32_i24 v161, v172, -8, v116
  v_mad_i32_i24 v162, v173, -2, v113
  v_mad_i32_i24 v163, v173, -8, v117
  v_mad_i32_i24 v164, v174, -2, v114
  v_mad_i32_i24 v165, v174, -8, v118
  v_mad_i32_i24 v166, v175, -2, v115
  v_mad_i32_i24 v167, v175, -8, v119
  ds_write_b128 v120, v[160:163]
  ds_write_b128 v120, v[164:167] offset:16
  s_cmp_eq_u32 s24, 0
  s_cbranch_scc1 K2_NOLD
  s_lshl_b32 s60, s28, 3
  s_add_u32 s60, s60, s13
  v_mov_b32 v24, s60
  v_mov_b32 v25, s63
  ds_write_b32 v25, v24 offset:224
  buffer_load_dwordx4 v[232:235], v20, s[32:35], s39 offen offset:0
  buffer_load_dwordx4 v[236:239], v20, s[32:35], s39 offen offset:1024
  buffer_load_dwordx4 v[48:51], v20, s[32:35], s39 offen offset:2048
  buffer_load_dwordx4 v[96:99], v20, s[32:35], s38 offen offset:1024
  buffer_load_dwordx4 v[100:103], v20, s[32:35], s38 offen offset:2048
  v_and_b32 v24, 7, v252
  v_lshlrev_b32 v24, 8, v24
  v_mov_b32 v25, 0
  s_mov_b32 s20, 1
  s_mov_b32 s24, 0
  s_mov_b32 s22, 0
  s_mov_b64 s[36:37], -1
  s_xor_b32 s61, s13, 7
  s_and_b32 s60, s13, 3
  s_cmp_lt_u32 s13, 4
  s_cselect_b32 s61, s61, s60
  s_cselect_b64 s[54:55], 0, -1
  s_sub_u32 s26, s26, s13
  v_mov_b32 v246, 0
  v_mov_b32 v247, 0
  s_mov_b32 s8, 5242880
  s_mov_b32 s4, 2621440
  s_mov_b32 s5, 2620416
  s_mov_b32 s6, 2619392
  s_mov_b32 s7, 2618368
  v_lshlrev_b32 v127, 3, v252
  v_add_u32 v22, 0x10000800, v126
  v_add_u32 v126, 0x10000000, v126
  s_waitcnt vmcnt(5) lgkmcnt(0)
  s_barrier
  ds_read_b32 v24, v24 offset:224
  s_waitcnt lgkmcnt(0)
  v_sub_co_u32_dpp v26, vcc, v24, v24 row_ror:1 row_mask:0xf bank_mask:0xf
  v_addc_co_u32 v25, vcc, 0, v25, vcc
  v_sub_co_u32_dpp v26, vcc, v24, v24 row_ror:2 row_mask:0xf bank_mask:0xf
  v_addc_co_u32 v25, vcc, 0, v25, vcc
  v_sub_co_u32_dpp v26, vcc, v24, v24 row_ror:3 row_mask:0xf bank_mask:0xf
  v_addc_co_u32 v25, vcc, 0, v25, vcc
  v_sub_co_u32_dpp v26, vcc, v24, v24 row_ror:4 row_mask:0xf bank_mask:0xf
  v_addc_co_u32 v25, vcc, 0, v25, vcc
  v_sub_co_u32_dpp v26, vcc, v24, v24 row_ror:5 row_mask:0xf bank_mask:0xf
  v_addc_co_u32 v25, vcc, 0, v25, vcc
  v_sub_co_u32_dpp v26, vcc, v24, v24 row_ror:6 row_mask:0xf bank_mask:0xf
  v_addc_co_u32 v25, vcc, 0, v25, vcc
  v_sub_co_u32_dpp v26, vcc, v24, v24 row_ror:7 row_mask:0xf bank_mask:0xf
  v_addc_co_u32 v25, vcc, 0, v25, vcc
  v_cmp_eq_u32 vcc, s61, v25
  s_ff1_i32_b32 s13, vcc_lo
  s_mul_i32 s27, s13, 16032
  s_add_u32 s27, s27, 34816
  s_add_u32 s0, s27, 4096
  v_add_u32 v125, s0, v20
  v_readlane_b32 s28, v24, s13
  ds_read_b128 v[140:143], v125
  ds_read_b128 v[144:147], v125 offset:1024
  s_add_u32 s26, s26, s13
  s_add_u32 s1, s27, 8192
  s_lshl_b32 s63, s13, 8
  s_mul_i32 s40, s26, 640
  s_mul_i32 s25, s26, 768
  s_add_u32 s25, s25, 3407872
  s_lshr_b32 s28, s28, 3
  v_mov_b32 v251, s63
  v_and_b32 v26, 31, v252
  v_lshrrev_b32 v27, 5, v252
  v_mul_u32_u24 v26, 12, v26
  v_mad_u32_u24 v26, v27, s25, v26
  buffer_load_dwordx3 v[104:106], v26, s[32:35], s38 offen offset:0
  buffer_load_dwordx3 v[108:110], v26, s[32:35], s38 offen offset:384
  s_mul_i32 s16, s26, 80
  s_sub_u32 s16, s16, 144
  v_add_u32 v26, s16, v20
  s_mov_b64 exec, 0x1ff
  v_add_u32 v26, 6847232, v20
  s_mov_b64 exec, 0x3fff
  s_mov_b32 m0, s63
  s_nop 0
  buffer_load_dwordx4 v26, s[32:35], s17 offen lds
  s_add_u32 m0, s27, 15392
  s_bfm_b64 exec, 40, 0
  buffer_load_dwordx4 v20, s[44:47], s40 offen lds
  s_mov_b64 exec, -1
  s_branch K2_LD2
  s_nop 0
  s_nop 0
  s_nop 0
  s_nop 0
  s_nop 0
  s_nop 0
  s_nop 0
K2_NOLD:
  v_lshlrev_b32 v127, 3, v252
  v_add_u32 v22, 0x10000800, v126
  v_add_u32 v126, 0x10000000, v126
  ds_read_b128 v[140:143], v125
  ds_read_b128 v[144:147], v125 offset:1024
K2_LD2:
  s_sub_u32 s21, s28, s29
  s_min_u32 s21, s21, 448
  s_add_u32 s60, s29, 448
  s_cmp_ge_u32 s60, s28
  s_cselect_b32 s23, 1, 0
  s_or_b64 s[2:3], s[64:65], s[66:67]
  s_or_b64 s[2:3], s[2:3], s[68:69]
  s_or_b64 s[2:3], s[2:3], s[70:71]
  s_cselect_b32 s23, 0, s23
  s_waitcnt lgkmcnt(1)
  v_max_u32 v141, v140, v141
  v_max_u32 v142, v141, v142
  v_max_u32 v143, v142, v143
  s_waitcnt lgkmcnt(0)
  v_max_u32 v145, v144, v145
  v_max_u32 v146, v145, v146
  v_max_u32 v147, v146, v147
  v_mov_b32 v148, v143
  v_mov_b32 v149, v147
  s_nop 0
  v_max_u32_dpp v148, v148, v148 row_shr:1 row_mask:0xf bank_mask:0xf
  v_max_u32_dpp v149, v149, v149 row_shr:1 row_mask:0xf bank_mask:0xf
  s_nop 0
  v_max_u32_dpp v148, v148, v148 row_shr:2 row_mask:0xf bank_mask:0xf
  v_max_u32_dpp v149, v149, v149 row_shr:2 row_mask:0xf bank_mask:0xf
  s_nop 0
  v_max_u32_dpp v148, v148, v148 row_shr:4 row_mask:0xf bank_mask:0xf
  v_max_u32_dpp v149, v149, v149 row_shr:4 row_mask:0xf bank_mask:0xf
  s_nop 0
  v_max_u32_dpp v148, v148, v148 row_shr:8 row_mask:0xf bank_mask:0xf
  v_max_u32_dpp v149, v149, v149 row_shr:8 row_mask:0xf bank_mask:0xf
  s_nop 0
  v_max_u32_dpp v148, v148, v148 row_bcast:15 row_mask:0xa bank_mask:0xf
  v_max_u32_dpp v149, v149, v149 row_bcast:15 row_mask:0xa bank_mask:0xf
  s_nop 0
  v_max_u32_dpp v148, v148, v148 row_bcast:31 row_mask:0xc bank_mask:0xf
  v_max_u32_dpp v149, v149, v149 row_bcast:31 row_mask:0xc bank_mask:0xf
  s_nop 0
  v_mov_b32_dpp v150, v148 wave_shr:1 row_mask:0xf bank_mask:0xf bound_ctrl:0
  v_mov_b32_dpp v151, v149 wave_shr:1 row_mask:0xf bank_mask:0xf bound_ctrl:0
  v_readlane_b32 s60, v148, 63
  v_max_u32 v140, v140, v150
  v_max_u32 v141, v141, v150
  v_max_u32 v142, v142, v150
  v_max_u32 v143, v143, v150
  ds_read_b64 v[176:177], v140
  ds_read_b64 v[178:179], v141
  ds_read_b64 v[180:181], v142
  ds_read_b64 v[182:183], v143
  v_max_u32 v151, s60, v151
  v_max_u32 v144, v144, v151
  v_max_u32 v145, v145, v151
  v_max_u32 v146, v146, v151
  v_max_u32 v147, v147, v151
  ds_read_b64 v[184:185], v144
  ds_read_b64 v[186:187], v145
  ds_read_b64 v[188:189], v146
  ds_read_b64 v[190:191], v147
  v_add_u32 v23, s27, v20
  v_lshlrev_b32 v249, 2, v252
  v_add_u32 v249, s27, v249
  v_lshrrev_b32 v248, 3, v252
  v_lshl_add_u32 v248, v248, 4, s27
  s_waitcnt lgkmcnt(4)
  v_add_u32 v176, v176, v127
  v_add_u32 v178, v178, v127
  v_add_u32 v180, v180, v127
  v_add_u32 v182, v182, v127
  ds_read_u16 v0, v176 offset:0
  ds_read_u16 v1, v178 offset:2
  ds_read_u16 v2, v180 offset:4
  ds_read_u16 v3, v182 offset:6
  v_add3_u32 v8, v177, v126, 0
  v_add3_u32 v9, v179, v126, 8
  v_add3_u32 v10, v181, v126, 16
  v_add3_u32 v11, v183, v126, 24
  s_waitcnt lgkmcnt(4)
  v_add_u32 v184, v184, v127
  v_add_u32 v186, v186, v127
  v_add_u32 v188, v188, v127
  v_add_u32 v190, v190, v127
  v_add3_u32 v156, v185, v22, 0
  v_add3_u32 v157, v187, v22, 8
  v_add3_u32 v158, v189, v22, 16
  v_add3_u32 v159, v191, v22, 24
  s_waitcnt lgkmcnt(3)
  v_mul_u32_u24 v140, 0xcccd, v0
  s_waitcnt lgkmcnt(2)
  v_mul_u32_u24 v141, 0xcccd, v1
  s_waitcnt lgkmcnt(1)
  v_mul_u32_u24 v142, 0xcccd, v2
  s_waitcnt lgkmcnt(0)
  v_mul_u32_u24 v143, 0xcccd, v3
  v_lshrrev_b32 v140, 18, v140
  v_lshrrev_b32 v141, 18, v141
  v_lshrrev_b32 v142, 18, v142
  v_lshrrev_b32 v143, 18, v143
  v_mad_i32_i24 v0, v140, -5, v0
  v_mad_i32_i24 v1, v141, -5, v1
  v_mad_i32_i24 v2, v142, -5, v2
  v_mad_i32_i24 v3, v143, -5, v3
  v_lshlrev_b32 v140, 7, v140
  v_lshlrev_b32 v141, 7, v141
  v_lshlrev_b32 v142, 7, v142
  v_lshlrev_b32 v143, 7, v143
  v_lshl_add_u32 v8, v0, 28, v8
  v_lshl_add_u32 v9, v1, 28, v9
  v_lshl_add_u32 v10, v2, 28, v10
  v_lshl_add_u32 v11, v3, 28, v11
  ds_write_b128 v23, v[140:143] offset:0
  ds_write_b128 v23, v[8:11] offset:2048
K2_RUN:
  s_add_u32 s30, s21, 31
  s_lshr_b32 s30, s30, 5
  s_cmp_eq_u32 s30, 0
  s_cbranch_scc1 K2_WEND
  s_cmp_lt_u32 s21, 64
  s_cselect_b32 s60, 1, s22
  s_cmp_lg_u32 s60, 0
  s_cbranch_scc1 K2_PAD0
K2_PAD0R:
  ds_read2st64_b32 v[2:3], v249 offset0:0 offset1:8
  ds_read_b128 v[224:227], v248
  ds_read_b128 v[140:143], v248 offset:128
  s_cmp_lg_u32 s22, 0
  s_waitcnt vmcnt(4)
  s_waitcnt lgkmcnt(2)
  v_or_b32_sdwa v243, v251, v3 dst_sel:DWORD dst_unused:UNUSED_PAD src0_sel:DWORD src1_sel:BYTE_3
  v_lshrrev_b32 v2, 3, v2
  v_and_b32 v3, 0xffffff, v3
  buffer_load_dwordx2 v[128:129], v3, s[32:35], s8 offen
  buffer_load_dwordx3 v[240:242], v2, s[32:35], s17 offen
  s_waitcnt lgkmcnt(1)
  s_mov_b32 m0, s0
  v_pk_add_f32 v[224:225], v[224:225], v[232:233] op_sel_hi:[1,0]
  v_pk_add_f32 v[226:227], v[226:227], v[232:233] op_sel_hi:[1,0]
  buffer_load_dwordx4 v224, s[32:35], s4 offen offset:0 lds
  buffer_load_dwordx4 v225, s[32:35], s5 offen offset:1024 lds
  buffer_load_dwordx4 v226, s[32:35], s6 offen offset:2048 lds
  buffer_load_dwordx4 v227, s[32:35], s7 offen offset:3072 lds
  s_cbranch_scc1 K2_NOH1X
  ds_read_u16 v152, v184 offset:512
  ds_read_u16 v153, v186 offset:514
  ds_read_u16 v154, v188 offset:516
  ds_read_u16 v155, v190 offset:518
  s_waitcnt lgkmcnt(3)
  v_mul_u32_u24 v144, 0xcccd, v152
  s_waitcnt lgkmcnt(2)
  v_mul_u32_u24 v145, 0xcccd, v153
  s_waitcnt lgkmcnt(1)
  v_mul_u32_u24 v146, 0xcccd, v154
  s_waitcnt lgkmcnt(0)
  v_mul_u32_u24 v147, 0xcccd, v155
  v_lshrrev_b32 v144, 18, v144
  v_lshrrev_b32 v145, 18, v145
  v_lshrrev_b32 v146, 18, v146
  v_lshrrev_b32 v147, 18, v147
  v_mad_i32_i24 v152, v144, -5, v152
  v_mad_i32_i24 v153, v145, -5, v153
  v_mad_i32_i24 v154, v146, -5, v154
  v_mad_i32_i24 v155, v147, -5, v155
  v_lshlrev_b32 v144, 7, v144
  v_lshlrev_b32 v145, 7, v145
  v_lshlrev_b32 v146, 7, v146
  v_lshlrev_b32 v147, 7, v147
  v_lshl_add_u32 v156, v152, 28, v156
  v_lshl_add_u32 v157, v153, 28, v157
  v_lshl_add_u32 v158, v154, 28, v158
  v_lshl_add_u32 v159, v155, 28, v159
  s_mov_b32 exec_hi, 0xffff
  ds_write_b128 v23, v[144:147] offset:1024
  ds_write_b128 v23, v[156:159] offset:3072
  s_mov_b32 exec_hi, -1
  s_sub_u32 s60, 0, s21
  s_and_b32 s60, s60, 63
  s_lshl_b32 s61, s21, 2
  v_add_u32 v4, s61, v249
  ds_write2st64_b32 v4, v246, v246 offset0:0 offset1:8
  s_bfm_b64 exec, s60, 0
  ds_write2st64_b32 v4, v246, v246 offset0:1 offset1:9
  s_mov_b64 exec, -1
K2_NOH1:
  s_mov_b32 m0, s1
  v_pk_add_f32 v[140:141], v[140:141], v[232:233] op_sel_hi:[1,0]
  v_pk_add_f32 v[142:143], v[142:143], v[232:233] op_sel_hi:[1,0]
  buffer_load_dwordx4 v140, s[32:35], s4 offen offset:0 lds
  buffer_load_dwordx4 v141, s[32:35], s5 offen offset:1024 lds
  buffer_load_dwordx4 v142, s[32:35], s6 offen offset:2048 lds
  buffer_load_dwordx4 v143, s[32:35], s7 offen offset:3072 lds
  s_cmp_eq_u32 s20, 0
  s_cbranch_scc1 K2_NF
  s_sub_u32 s60, s27, s63
  s_add_u32 s61, s27, 12288
  v_add_u32 v26, s61, v20
  ds_write_b128 v26, v[136:139]
  ds_write_b128 v26, v[136:139] offset:1024
  ds_write_b128 v26, v[136:139] offset:2048
  v_add_u32 v233, s27, v233
  v_add_u32 v234, s27, v234
  v_add_u32 v235, s60, v235
  v_add_u32 v236, s27, v236
  v_add_u32 v237, s27, v237
  v_add_u32 v238, s27, v238
  v_add_u32 v239, s63, v239
  s_mov_b32 s50, 1340000
  s_mov_b32 s51, 0x20000
  s_movk_i32 s41, 0x207
  s_movk_i32 s52, 256
  s_movk_i32 s53, 256
  s_mov_b32 s20, 0
  v_mov_b32 v107, 0
  v_mov_b32 v111, 0
  v_mov_b32 v131, 0
K2_NFR:
  s_waitcnt vmcnt(10)
  ds_read_b128 v[228:231], v243 offset:128
  ds_read_b128 v[132:135], v243
  ds_read_b128 v[224:227], v248 offset:256
  ds_read2st64_b32 v[140:141], v249 offset0:1 offset1:9
  ds_read_b128 v[144:147], v248 offset:384
  s_waitcnt vmcnt(4)
  ds_read_b64_tr_b16 v[112:113], v233 offset:0
  ds_read_b64_tr_b16 v[114:115], v233 offset:1024
  ds_read_b64_tr_b16 v[120:121], v234 offset:0
  ds_read_b64_tr_b16 v[122:123], v234 offset:1024
  ds_read_b64_tr_b16 v[116:117], v233 offset:2048
  ds_read_b64_tr_b16 v[118:119], v233 offset:3072
  ds_read_b64_tr_b16 v[124:125], v234 offset:2048
  ds_read_b64_tr_b16 v[126:127], v234 offset:3072
  s_waitcnt lgkmcnt(11)
  v_pk_add_f32 v[228:229], v[228:229], v[240:241] neg_lo:[0,1] neg_hi:[0,1]
  v_sub_f32 v230, v230, v242
  v_add_u32 v250, v235, v243
  v_mul_f32 v253, v228, v228
  v_fmac_f32 v253, v229, v229
  v_fmac_f32 v253, v230, v230
  v_cvt_pk_bf16_f32 v130, v253, v253
  v_cvt_pk_f16_f32 v244, 1.0, v228
  v_cvt_pk_f16_f32 v245, v229, v230
  ds_write_b64 v250, v[244:245]
  v_permlane32_swap_b32 v128, v132
  v_permlane32_swap_b32 v129, v133
  v_permlane32_swap_b32 v130, v134
  ds_read_b64_tr_b16 v[208:209], v236 offset:0
  ds_read_b64_tr_b16 v[210:211], v236 offset:384
  ds_read_b64_tr_b16 v[212:213], v236 offset:768
  ds_read_b64_tr_b16 v[214:215], v236 offset:1152
  s_waitcnt lgkmcnt(13)
  v_pk_add_f32 v[224:225], v[224:225], v[232:233] op_sel_hi:[1,0]
  v_pk_add_f32 v[226:227], v[226:227], v[232:233] op_sel_hi:[1,0]
  s_mov_b32 m0, s0
  s_waitcnt lgkmcnt(11)
  v_mfma_f32_32x32x16_bf16 v[0:15], v[96:99], v[112:115], 0
  s_waitcnt lgkmcnt(9)
  v_mfma_f32_32x32x16_bf16 v[16:31], v[96:99], v[120:123], 0
  s_waitcnt lgkmcnt(7)
  v_mfma_f32_32x32x16_bf16 v[0:15], v[100:103], v[116:119], v[0:15]
  s_waitcnt lgkmcnt(5)
  v_mfma_f32_32x32x16_bf16 v[16:31], v[100:103], v[124:127], v[16:31]
  v_mfma_f32_32x32x16_bf16 v[0:15], v[128:131], v[104:107], v[0:15]
  v_mfma_f32_32x32x16_bf16 v[16:31], v[128:131], v[108:111], v[16:31]
  v_mov_b32 v228, v140
  v_mov_b32 v229, v141
  buffer_load_dwordx4 v224, s[32:35], s4 offen offset:0 lds
  buffer_load_dwordx4 v225, s[32:35], s5 offen offset:1024 lds
  buffer_load_dwordx4 v226, s[32:35], s6 offen offset:2048 lds
  buffer_load_dwordx4 v227, s[32:35], s7 offen offset:3072 lds
  v_pk_add_f32 v[224:225], v[144:145], v[232:233] op_sel_hi:[1,0]
  v_pk_add_f32 v[226:227], v[146:147], v[232:233] op_sel_hi:[1,0]
  v_or_b32_sdwa v243, v251, v229 dst_sel:DWORD dst_unused:UNUSED_PAD src0_sel:DWORD src1_sel:BYTE_3
  v_lshrrev_b32 v228, 3, v228
  v_and_b32 v229, 0xffffff, v229
  s_mov_b64 vcc, s[54:55]
  s_sub_u32 s31, s30, 2
  s_setprio 0
  s_nop 2
  s_waitcnt lgkmcnt(0)
  s_cbranch_scc1 K2_TAIL0
K2_LOOP:
  s_waitcnt vmcnt(4)
  v_cvt_pk_f16_f32 v160, v0, v1
  v_cvt_pk_f16_f32 v161, v2, v3
  ds_read_b64_tr_b16 v[112:113], v233 offset:4096
  v_cvt_pk_f16_f32 v162, v4, v5
  ds_read_b64_tr_b16 v[114:115], v233 offset:5120
  v_cvt_pk_f16_f32 v163, v6, v7
  ds_read_b64_tr_b16 v[120:121], v234 offset:4096
  v_cvt_pk_f16_f32 v164, v8, v9
  ds_read_b64_tr_b16 v[122:123], v234 offset:5120
  v_cvt_pk_f16_f32 v165, v10, v11
  v_mfma_f32_32x32x16_f16 v[64:79], v[216:219], v[192:195], v[64:79]
  v_cvt_pk_f16_f32 v166, v12, v13
  ds_read_b64_tr_b16 v[116:117], v233 offset:6144
  v_cvt_pk_f16_f32 v167, v14, v15
  ds_read_b64_tr_b16 v[118:119], v233 offset:7168
  v_cvt_pk_f16_f32 v168, v16, v17
  ds_read_b64_tr_b16 v[124:125], v234 offset:6144
  v_cvt_pk_f16_f32 v169, v18, v19
  ds_read_b64_tr_b16 v[126:127], v234 offset:7168
  v_cvt_pk_f16_f32 v170, v20, v21
  v_cvt_pk_f16_f32 v171, v22, v23
  buffer_load_dwordx2 v[128:129], v229, s[32:35], s8 offen
  v_cvt_pk_f16_f32 v172, v24, v25
  buffer_load_dwordx3 v[240:242], v228, s[32:35], s17 offen
  v_cvt_pk_f16_f32 v173, v26, v27
  v_mfma_f32_32x32x16_f16 v[80:95], v[216:219], v[200:203], v[80:95]
  v_cvt_pk_f16_f32 v174, v28, v29
  v_cvt_pk_f16_f32 v175, v30, v31
  s_mov_b32 m0, s1
  s_setprio 1
  v_exp_f16_sdwa v176, v160 dst_sel:WORD_0 dst_unused:UNUSED_PAD src0_sel:WORD_0
  v_exp_f16_sdwa v177, v161 dst_sel:WORD_0 dst_unused:UNUSED_PAD src0_sel:WORD_0
  v_exp_f16_sdwa v178, v162 dst_sel:WORD_0 dst_unused:UNUSED_PAD src0_sel:WORD_0
  v_mfma_f32_32x32x16_f16 v[64:79], v[220:223], v[196:199], v[64:79]
  v_exp_f16_sdwa v179, v163 dst_sel:WORD_0 dst_unused:UNUSED_PAD src0_sel:WORD_0
  v_exp_f16_sdwa v180, v164 dst_sel:WORD_0 dst_unused:UNUSED_PAD src0_sel:WORD_0
  v_exp_f16_sdwa v181, v165 dst_sel:WORD_0 dst_unused:UNUSED_PAD src0_sel:WORD_0
  v_exp_f16_sdwa v182, v166 dst_sel:WORD_0 dst_unused:UNUSED_PAD src0_sel:WORD_0
  v_exp_f16_sdwa v183, v167 dst_sel:WORD_0 dst_unused:UNUSED_PAD src0_sel:WORD_0
  v_exp_f16_sdwa v184, v168 dst_sel:WORD_0 dst_unused:UNUSED_PAD src0_sel:WORD_0
  v_mfma_f32_32x32x16_f16 v[80:95], v[220:223], v[204:207], v[80:95]
  v_exp_f16_sdwa v185, v169 dst_sel:WORD_0 dst_unused:UNUSED_PAD src0_sel:WORD_0
  v_exp_f16_sdwa v186, v170 dst_sel:WORD_0 dst_unused:UNUSED_PAD src0_sel:WORD_0
  s_sub_u32 s31, s31, 1
  s_waitcnt lgkmcnt(0)
  v_exp_f16_sdwa v187, v171 dst_sel:WORD_0 dst_unused:UNUSED_PAD src0_sel:WORD_0
  v_exp_f16_sdwa v188, v172 dst_sel:WORD_0 dst_unused:UNUSED_PAD src0_sel:WORD_0
  v_mfma_f32_32x32x16_bf16 v[0:15], v[96:99], v[112:115], 0
  v_exp_f16_sdwa v189, v173 dst_sel:WORD_0 dst_unused:UNUSED_PAD src0_sel:WORD_0
  buffer_load_dwordx4 v224, s[32:35], s4 offen offset:0 lds
  v_exp_f16_sdwa v190, v174 dst_sel:WORD_0 dst_unused:UNUSED_PAD src0_sel:WORD_0
  buffer_load_dwordx4 v225, s[32:35], s5 offen offset:1024 lds
  v_exp_f16_sdwa v191, v175 dst_sel:WORD_0 dst_unused:UNUSED_PAD src0_sel:WORD_0
  buffer_load_dwordx4 v226, s[32:35], s6 offen offset:2048 lds
  v_exp_f16_sdwa v176, v160 dst_sel:WORD_1 dst_unused:UNUSED_PRESERVE src0_sel:WORD_1
  buffer_load_dwordx4 v227, s[32:35], s7 offen offset:3072 lds
  v_exp_f16_sdwa v177, v161 dst_sel:WORD_1 dst_unused:UNUSED_PRESERVE src0_sel:WORD_1
  v_exp_f16_sdwa v178, v162 dst_sel:WORD_1 dst_unused:UNUSED_PRESERVE src0_sel:WORD_1
  v_exp_f16_sdwa v179, v163 dst_sel:WORD_1 dst_unused:UNUSED_PRESERVE src0_sel:WORD_1
  v_mfma_f32_32x32x16_bf16 v[16:31], v[96:99], v[120:123], 0
  v_exp_f16_sdwa v180, v164 dst_sel:WORD_1 dst_unused:UNUSED_PRESERVE src0_sel:WORD_1
  ds_read_b64_tr_b16 v[216:217], v236 offset:1536
  v_exp_f16_sdwa v181, v165 dst_sel:WORD_1 dst_unused:UNUSED_PRESERVE src0_sel:WORD_1
  ds_read_b64_tr_b16 v[218:219], v236 offset:1920
  v_exp_f16_sdwa v182, v166 dst_sel:WORD_1 dst_unused:UNUSED_PRESERVE src0_sel:WORD_1
  ds_read_b64_tr_b16 v[220:221], v236 offset:2304
  v_exp_f16_sdwa v183, v167 dst_sel:WORD_1 dst_unused:UNUSED_PRESERVE src0_sel:WORD_1
  ds_read_b64_tr_b16 v[222:223], v236 offset:2688
  v_exp_f16_sdwa v184, v168 dst_sel:WORD_1 dst_unused:UNUSED_PRESERVE src0_sel:WORD_1
  ds_write_b64 v250, v[246:247]
  v_exp_f16_sdwa v185, v169 dst_sel:WORD_1 dst_unused:UNUSED_PRESERVE src0_sel:WORD_1
  v_exp_f16_sdwa v186, v170 dst_sel:WORD_1 dst_unused:UNUSED_PRESERVE src0_sel:WORD_1
  v_mfma_f32_32x32x16_bf16 v[0:15], v[100:103], v[116:119], v[0:15]
  v_exp_f16_sdwa v187, v171 dst_sel:WORD_1 dst_unused:UNUSED_PRESERVE src0_sel:WORD_1
  v_exp_f16_sdwa v188, v172 dst_sel:WORD_1 dst_unused:UNUSED_PRESERVE src0_sel:WORD_1
  v_exp_f16_sdwa v189, v173 dst_sel:WORD_1 dst_unused:UNUSED_PRESERVE src0_sel:WORD_1
  v_exp_f16_sdwa v190, v174 dst_sel:WORD_1 dst_unused:UNUSED_PRESERVE src0_sel:WORD_1
  v_exp_f16_sdwa v191, v175 dst_sel:WORD_1 dst_unused:UNUSED_PRESERVE src0_sel:WORD_1
  v_pk_add_f16 v176, v176, 1.0 op_sel_hi:[1,0]
  v_pk_add_f16 v177, v177, 1.0 op_sel_hi:[1,0]
  v_pk_add_f16 v178, v178, 1.0 op_sel_hi:[1,0]
  v_pk_add_f16 v179, v179, 1.0 op_sel_hi:[1,0]
  v_pk_add_f16 v180, v180, 1.0 op_sel_hi:[1,0]
  v_pk_add_f16 v181, v181, 1.0 op_sel_hi:[1,0]
  v_pk_add_f16 v182, v182, 1.0 op_sel_hi:[1,0]
  v_pk_add_f16 v183, v183, 1.0 op_sel_hi:[1,0]
  v_pk_add_f16 v184, v184, 1.0 op_sel_hi:[1,0]
  v_pk_add_f16 v185, v185, 1.0 op_sel_hi:[1,0]
  v_pk_add_f16 v186, v186, 1.0 op_sel_hi:[1,0]
  v_pk_add_f16 v187, v187, 1.0 op_sel_hi:[1,0]
  v_pk_add_f16 v188, v188, 1.0 op_sel_hi:[1,0]
  v_pk_add_f16 v189, v189, 1.0 op_sel_hi:[1,0]
  v_pk_add_f16 v190, v190, 1.0 op_sel_hi:[1,0]
  v_pk_add_f16 v191, v191, 1.0 op_sel_hi:[1,0]
  v_rcp_f16_sdwa v176, v176 dst_sel:WORD_0 dst_unused:UNUSED_PRESERVE src0_sel:WORD_0
  v_rcp_f16_sdwa v177, v177 dst_sel:WORD_0 dst_unused:UNUSED_PRESERVE src0_sel:WORD_0
  v_mfma_f32_32x32x16_bf16 v[16:31], v[100:103], v[124:127], v[16:31]
  v_rcp_f16_sdwa v178, v178 dst_sel:WORD_0 dst_unused:UNUSED_PRESERVE src0_sel:WORD_0
  v_rcp_f16_sdwa v179, v179 dst_sel:WORD_0 dst_unused:UNUSED_PRESERVE src0_sel:WORD_0
  ds_read_b128 v[224:227], v248 offset:512
  v_rcp_f16_sdwa v180, v180 dst_sel:WORD_0 dst_unused:UNUSED_PRESERVE src0_sel:WORD_0
  v_rcp_f16_sdwa v181, v181 dst_sel:WORD_0 dst_unused:UNUSED_PRESERVE src0_sel:WORD_0
  v_rcp_f16_sdwa v182, v182 dst_sel:WORD_0 dst_unused:UNUSED_PRESERVE src0_sel:WORD_0
  v_rcp_f16_sdwa v183, v183 dst_sel:WORD_0 dst_unused:UNUSED_PRESERVE src0_sel:WORD_0
  v_rcp_f16_sdwa v184, v184 dst_sel:WORD_0 dst_unused:UNUSED_PRESERVE src0_sel:WORD_0
  v_rcp_f16_sdwa v185, v185 dst_sel:WORD_0 dst_unused:UNUSED_PRESERVE src0_sel:WORD_0
  v_rcp_f16_sdwa v186, v186 dst_sel:WORD_0 dst_unused:UNUSED_PRESERVE src0_sel:WORD_0
  v_mfma_f32_32x32x16_bf16 v[0:15], v[132:135], v[104:107], v[0:15]
  v_rcp_f16_sdwa v187, v187 dst_sel:WORD_0 dst_unused:UNUSED_PRESERVE src0_sel:WORD_0
  v_rcp_f16_sdwa v188, v188 dst_sel:WORD_0 dst_unused:UNUSED_PRESERVE src0_sel:WORD_0
  v_rcp_f16_sdwa v189, v189 dst_sel:WORD_0 dst_unused:UNUSED_PRESERVE src0_sel:WORD_0
  v_rcp_f16_sdwa v190, v190 dst_sel:WORD_0 dst_unused:UNUSED_PRESERVE src0_sel:WORD_0
  v_rcp_f16_sdwa v191, v191 dst_sel:WORD_0 dst_unused:UNUSED_PRESERVE src0_sel:WORD_0
  v_rcp_f16_sdwa v176, v176 dst_sel:WORD_1 dst_unused:UNUSED_PRESERVE src0_sel:WORD_1
  v_rcp_f16_sdwa v177, v177 dst_sel:WORD_1 dst_unused:UNUSED_PRESERVE src0_sel:WORD_1
  v_rcp_f16_sdwa v178, v178 dst_sel:WORD_1 dst_unused:UNUSED_PRESERVE src0_sel:WORD_1
  v_rcp_f16_sdwa v179, v179 dst_sel:WORD_1 dst_unused:UNUSED_PRESERVE src0_sel:WORD_1
  v_mfma_f32_32x32x16_bf16 v[16:31], v[132:135], v[108:111], v[16:31]
  v_rcp_f16_sdwa v180, v180 dst_sel:WORD_1 dst_unused:UNUSED_PRESERVE src0_sel:WORD_1
  v_rcp_f16_sdwa v181, v181 dst_sel:WORD_1 dst_unused:UNUSED_PRESERVE src0_sel:WORD_1
  v_rcp_f16_sdwa v182, v182 dst_sel:WORD_1 dst_unused:UNUSED_PRESERVE src0_sel:WORD_1
  v_rcp_f16_sdwa v183, v183 dst_sel:WORD_1 dst_unused:UNUSED_PRESERVE src0_sel:WORD_1
  v_rcp_f16_sdwa v184, v184 dst_sel:WORD_1 dst_unused:UNUSED_PRESERVE src0_sel:WORD_1
  v_rcp_f16_sdwa v185, v185 dst_sel:WORD_1 dst_unused:UNUSED_PRESERVE src0_sel:WORD_1
  v_rcp_f16_sdwa v186, v186 dst_sel:WORD_1 dst_unused:UNUSED_PRESERVE src0_sel:WORD_1
  v_rcp_f16_sdwa v187, v187 dst_sel:WORD_1 dst_unused:UNUSED_PRESERVE src0_sel:WORD_1
  v_rcp_f16_sdwa v188, v188 dst_sel:WORD_1 dst_unused:UNUSED_PRESERVE src0_sel:WORD_1
  v_rcp_f16_sdwa v189, v189 dst_sel:WORD_1 dst_unused:UNUSED_PRESERVE src0_sel:WORD_1
  v_rcp_f16_sdwa v190, v190 dst_sel:WORD_1 dst_unused:UNUSED_PRESERVE src0_sel:WORD_1
  s_setprio 0
  s_waitcnt lgkmcnt(0)
  v_rcp_f16_sdwa v191, v191 dst_sel:WORD_1 dst_unused:UNUSED_PRESERVE src0_sel:WORD_1
  v_pk_mul_f16 v192, v176, v160
  v_pk_mul_f16 v193, v177, v161
  v_pk_add_f32 v[224:225], v[224:225], v[232:233] op_sel_hi:[1,0]
  v_pk_mul_f16 v194, v178, v162
  v_pk_add_f32 v[226:227], v[226:227], v[232:233] op_sel_hi:[1,0]
  v_pk_mul_f16 v195, v179, v163
  v_pk_mul_f16 v196, v180, v164
  v_pk_mul_f16 v197, v181, v165
  v_pk_mul_f16 v198, v182, v166
  v_pk_mul_f16 v199, v183, v167
  v_pk_mul_f16 v200, v184, v168
  v_pk_mul_f16 v201, v185, v169
  v_pk_mul_f16 v202, v186, v170
  v_pk_mul_f16 v203, v187, v171
  v_pk_mul_f16 v204, v188, v172
  v_pk_mul_f16 v205, v189, v173
  v_pk_mul_f16 v206, v190, v174
  v_pk_mul_f16 v207, v191, v175
  s_cbranch_scc1 K2_TAIL1
  s_waitcnt vmcnt(6)
  v_cvt_pk_f16_f32 v160, v0, v1
  v_cvt_pk_f16_f32 v161, v2, v3
  ds_read_b64_tr_b16 v[112:113], v233 offset:0
  v_cvt_pk_f16_f32 v162, v4, v5
  ds_read_b64_tr_b16 v[114:115], v233 offset:1024
  v_cvt_pk_f16_f32 v163, v6, v7
  ds_read_b64_tr_b16 v[120:121], v234 offset:0
  v_cvt_pk_f16_f32 v164, v8, v9
  ds_read_b64_tr_b16 v[122:123], v234 offset:1024
  v_cvt_pk_f16_f32 v165, v10, v11
  v_mfma_f32_32x32x16_f16 v[64:79], v[208:211], v[192:195], v[64:79]
  v_cvt_pk_f16_f32 v166, v12, v13
  ds_read_b64_tr_b16 v[116:117], v233 offset:2048
  v_cvt_pk_f16_f32 v167, v14, v15
  ds_read_b64_tr_b16 v[118:119], v233 offset:3072
  v_cvt_pk_f16_f32 v168, v16, v17
  ds_read_b64_tr_b16 v[124:125], v234 offset:2048
  v_cvt_pk_f16_f32 v169, v18, v19
  ds_read_b64_tr_b16 v[126:127], v234 offset:3072
  v_cvt_pk_f16_f32 v170, v20, v21
  v_cvt_pk_f16_f32 v171, v22, v23
  ds_read_b128 v[228:231], v243 offset:128
  v_cvt_pk_f16_f32 v172, v24, v25
  ds_read_b128 v[132:135], v243
  v_cvt_pk_f16_f32 v173, v26, v27
  v_mfma_f32_32x32x16_f16 v[80:95], v[208:211], v[200:203], v[80:95]
  v_cvt_pk_f16_f32 v174, v28, v29
  v_cvt_pk_f16_f32 v175, v30, v31
  s_mov_b32 m0, s0
  s_setprio 1
  s_cbranch_vccz K2_YP1
  s_setprio 2
K2_YP1:
  v_exp_f16_sdwa v176, v160 dst_sel:WORD_0 dst_unused:UNUSED_PAD src0_sel:WORD_0
  v_exp_f16_sdwa v177, v161 dst_sel:WORD_0 dst_unused:UNUSED_PAD src0_sel:WORD_0
  v_exp_f16_sdwa v178, v162 dst_sel:WORD_0 dst_unused:UNUSED_PAD src0_sel:WORD_0
  v_mfma_f32_32x32x16_f16 v[64:79], v[212:215], v[196:199], v[64:79]
  v_exp_f16_sdwa v179, v163 dst_sel:WORD_0 dst_unused:UNUSED_PAD src0_sel:WORD_0
  v_exp_f16_sdwa v180, v164 dst_sel:WORD_0 dst_unused:UNUSED_PAD src0_sel:WORD_0
  v_exp_f16_sdwa v181, v165 dst_sel:WORD_0 dst_unused:UNUSED_PAD src0_sel:WORD_0
  v_exp_f16_sdwa v182, v166 dst_sel:WORD_0 dst_unused:UNUSED_PAD src0_sel:WORD_0
  v_exp_f16_sdwa v183, v167 dst_sel:WORD_0 dst_unused:UNUSED_PAD src0_sel:WORD_0
  v_exp_f16_sdwa v184, v168 dst_sel:WORD_0 dst_unused:UNUSED_PAD src0_sel:WORD_0
  v_mfma_f32_32x32x16_f16 v[80:95], v[212:215], v[204:207], v[80:95]
  v_exp_f16_sdwa v185, v169 dst_sel:WORD_0 dst_unused:UNUSED_PAD src0_sel:WORD_0
  v_exp_f16_sdwa v186, v170 dst_sel:WORD_0 dst_unused:UNUSED_PAD src0_sel:WORD_0
  s_sub_u32 s31, s31, 1
  s_waitcnt lgkmcnt(2)
  v_exp_f16_sdwa v187, v171 dst_sel:WORD_0 dst_unused:UNUSED_PAD src0_sel:WORD_0
  v_exp_f16_sdwa v188, v172 dst_sel:WORD_0 dst_unused:UNUSED_PAD src0_sel:WORD_0
  v_mfma_f32_32x32x16_bf16 v[0:15], v[96:99], v[112:115], 0
  v_exp_f16_sdwa v189, v173 dst_sel:WORD_0 dst_unused:UNUSED_PAD src0_sel:WORD_0
  buffer_load_dwordx4 v224, s[32:35], s4 offen offset:0 lds
  v_exp_f16_sdwa v190, v174 dst_sel:WORD_0 dst_unused:UNUSED_PAD src0_sel:WORD_0
  buffer_load_dwordx4 v225, s[32:35], s5 offen offset:1024 lds
  v_exp_f16_sdwa v191, v175 dst_sel:WORD_0 dst_unused:UNUSED_PAD src0_sel:WORD_0
  buffer_load_dwordx4 v226, s[32:35], s6 offen offset:2048 lds
  v_exp_f16_sdwa v176, v160 dst_sel:WORD_1 dst_unused:UNUSED_PRESERVE src0_sel:WORD_1
  buffer_load_dwordx4 v227, s[32:35], s7 offen offset:3072 lds
  v_exp_f16_sdwa v177, v161 dst_sel:WORD_1 dst_unused:UNUSED_PRESERVE src0_sel:WORD_1
  v_exp_f16_sdwa v178, v162 dst_sel:WORD_1 dst_unused:UNUSED_PRESERVE src0_sel:WORD_1
  v_exp_f16_sdwa v179, v163 dst_sel:WORD_1 dst_unused:UNUSED_PRESERVE src0_sel:WORD_1
  v_mfma_f32_32x32x16_bf16 v[16:31], v[96:99], v[120:123], 0
  v_exp_f16_sdwa v180, v164 dst_sel:WORD_1 dst_unused:UNUSED_PRESERVE src0_sel:WORD_1
  v_exp_f16_sdwa v181, v165 dst_sel:WORD_1 dst_unused:UNUSED_PRESERVE src0_sel:WORD_1
  v_exp_f16_sdwa v182, v166 dst_sel:WORD_1 dst_unused:UNUSED_PRESERVE src0_sel:WORD_1
  v_exp_f16_sdwa v183, v167 dst_sel:WORD_1 dst_unused:UNUSED_PRESERVE src0_sel:WORD_1
  v_exp_f16_sdwa v184, v168 dst_sel:WORD_1 dst_unused:UNUSED_PRESERVE src0_sel:WORD_1
  v_exp_f16_sdwa v185, v169 dst_sel:WORD_1 dst_unused:UNUSED_PRESERVE src0_sel:WORD_1
  v_exp_f16_sdwa v186, v170 dst_sel:WORD_1 dst_unused:UNUSED_PRESERVE src0_sel:WORD_1
  v_mfma_f32_32x32x16_bf16 v[0:15], v[100:103], v[116:119], v[0:15]
  v_exp_f16_sdwa v187, v171 dst_sel:WORD_1 dst_unused:UNUSED_PRESERVE src0_sel:WORD_1
  v_exp_f16_sdwa v188, v172 dst_sel:WORD_1 dst_unused:UNUSED_PRESERVE src0_sel:WORD_1
  v_exp_f16_sdwa v189, v173 dst_sel:WORD_1 dst_unused:UNUSED_PRESERVE src0_sel:WORD_1
  v_exp_f16_sdwa v190, v174 dst_sel:WORD_1 dst_unused:UNUSED_PRESERVE src0_sel:WORD_1
  v_add_u32 v250, v235, v243
  s_waitcnt vmcnt(8) lgkmcnt(0)
  v_exp_f16_sdwa v191, v175 dst_sel:WORD_1 dst_unused:UNUSED_PRESERVE src0_sel:WORD_1
  v_pk_add_f16 v176, v176, 1.0 op_sel_hi:[1,0]
  v_pk_add_f16 v177, v177, 1.0 op_sel_hi:[1,0]
  v_pk_add_f32 v[228:229], v[228:229], v[240:241] neg_lo:[0,1] neg_hi:[0,1]
  v_pk_add_f16 v178, v178, 1.0 op_sel_hi:[1,0]
  v_pk_add_f16 v179, v179, 1.0 op_sel_hi:[1,0]
  v_sub_f32_e64 v230, v230, v242
  v_pk_add_f16 v180, v180, 1.0 op_sel_hi:[1,0]
  v_pk_add_f16 v181, v181, 1.0 op_sel_hi:[1,0]
  v_pk_add_f16 v182, v182, 1.0 op_sel_hi:[1,0]
  v_pk_add_f16 v183, v183, 1.0 op_sel_hi:[1,0]
  v_mul_f32_e64 v253, v228, v228
  v_pk_add_f16 v184, v184, 1.0 op_sel_hi:[1,0]
  v_pk_add_f16 v185, v185, 1.0 op_sel_hi:[1,0]
  v_fmac_f32_e64 v253, v229, v229
  v_pk_add_f16 v186, v186, 1.0 op_sel_hi:[1,0]
  v_pk_add_f16 v187, v187, 1.0 op_sel_hi:[1,0]
  v_fmac_f32_e64 v253, v230, v230
  v_pk_add_f16 v188, v188, 1.0 op_sel_hi:[1,0]
  v_pk_add_f16 v189, v189, 1.0 op_sel_hi:[1,0]
  v_pk_add_f16 v190, v190, 1.0 op_sel_hi:[1,0]
  v_pk_add_f16 v191, v191, 1.0 op_sel_hi:[1,0]
  v_rcp_f16_sdwa v176, v176 dst_sel:WORD_0 dst_unused:UNUSED_PRESERVE src0_sel:WORD_0
  v_cvt_pk_bf16_f32 v130, v253, v253
  v_cvt_pk_f16_f32 v244, 1.0, v228
  v_cvt_pk_f16_f32 v245, v229, v230
  v_rcp_f16_sdwa v177, v177 dst_sel:WORD_0 dst_unused:UNUSED_PRESERVE src0_sel:WORD_0
  v_mfma_f32_32x32x16_bf16 v[16:31], v[100:103], v[124:127], v[16:31]
  v_rcp_f16_sdwa v178, v178 dst_sel:WORD_0 dst_unused:UNUSED_PRESERVE src0_sel:WORD_0
  v_permlane32_swap_b32_e64 v128, v132
  v_permlane32_swap_b32_e64 v129, v133
  v_permlane32_swap_b32_e64 v130, v134
  v_rcp_f16_sdwa v179, v179 dst_sel:WORD_0 dst_unused:UNUSED_PRESERVE src0_sel:WORD_0
  ds_read_b128 v[224:227], v248 offset:640
  v_rcp_f16_sdwa v180, v180 dst_sel:WORD_0 dst_unused:UNUSED_PRESERVE src0_sel:WORD_0
  ds_write_b64 v250, v[244:245]
  v_rcp_f16_sdwa v181, v181 dst_sel:WORD_0 dst_unused:UNUSED_PRESERVE src0_sel:WORD_0
  v_rcp_f16_sdwa v182, v182 dst_sel:WORD_0 dst_unused:UNUSED_PRESERVE src0_sel:WORD_0
  ds_read_b64_tr_b16 v[208:209], v236 offset:0
  v_rcp_f16_sdwa v183, v183 dst_sel:WORD_0 dst_unused:UNUSED_PRESERVE src0_sel:WORD_0
  ds_read_b64_tr_b16 v[210:211], v236 offset:384
  v_rcp_f16_sdwa v184, v184 dst_sel:WORD_0 dst_unused:UNUSED_PRESERVE src0_sel:WORD_0
  ds_read_b64_tr_b16 v[212:213], v236 offset:768
  v_rcp_f16_sdwa v185, v185 dst_sel:WORD_0 dst_unused:UNUSED_PRESERVE src0_sel:WORD_0
  ds_read_b64_tr_b16 v[214:215], v236 offset:1152
  v_rcp_f16_sdwa v186, v186 dst_sel:WORD_0 dst_unused:UNUSED_PRESERVE src0_sel:WORD_0
  v_mfma_f32_32x32x16_bf16 v[0:15], v[128:131], v[104:107], v[0:15]
  v_rcp_f16_sdwa v187, v187 dst_sel:WORD_0 dst_unused:UNUSED_PRESERVE src0_sel:WORD_0
  v_rcp_f16_sdwa v188, v188 dst_sel:WORD_0 dst_unused:UNUSED_PRESERVE src0_sel:WORD_0
  ds_read2st64_b32 v[228:229], v249 offset0:2 offset1:10
  v_rcp_f16_sdwa v189, v189 dst_sel:WORD_0 dst_unused:UNUSED_PRESERVE src0_sel:WORD_0
  v_rcp_f16_sdwa v190, v190 dst_sel:WORD_0 dst_unused:UNUSED_PRESERVE src0_sel:WORD_0
  v_rcp_f16_sdwa v191, v191 dst_sel:WORD_0 dst_unused:UNUSED_PRESERVE src0_sel:WORD_0
  v_rcp_f16_sdwa v176, v176 dst_sel:WORD_1 dst_unused:UNUSED_PRESERVE src0_sel:WORD_1
  v_rcp_f16_sdwa v177, v177 dst_sel:WORD_1 dst_unused:UNUSED_PRESERVE src0_sel:WORD_1
  v_rcp_f16_sdwa v178, v178 dst_sel:WORD_1 dst_unused:UNUSED_PRESERVE src0_sel:WORD_1
  v_rcp_f16_sdwa v179, v179 dst_sel:WORD_1 dst_unused:UNUSED_PRESERVE src0_sel:WORD_1
  v_mfma_f32_32x32x16_bf16 v[16:31], v[128:131], v[108:111], v[16:31]
  v_rcp_f16_sdwa v180, v180 dst_sel:WORD_1 dst_unused:UNUSED_PRESERVE src0_sel:WORD_1
  v_rcp_f16_sdwa v181, v181 dst_sel:WORD_1 dst_unused:UNUSED_PRESERVE src0_sel:WORD_1
  v_rcp_f16_sdwa v182, v182 dst_sel:WORD_1 dst_unused:UNUSED_PRESERVE src0_sel:WORD_1
  v_rcp_f16_sdwa v183, v183 dst_sel:WORD_1 dst_unused:UNUSED_PRESERVE src0_sel:WORD_1
  v_rcp_f16_sdwa v184, v184 dst_sel:WORD_1 dst_unused:UNUSED_PRESERVE src0_sel:WORD_1
  v_rcp_f16_sdwa v185, v185 dst_sel:WORD_1 dst_unused:UNUSED_PRESERVE src0_sel:WORD_1
  v_rcp_f16_sdwa v186, v186 dst_sel:WORD_1 dst_unused:UNUSED_PRESERVE src0_sel:WORD_1
  v_rcp_f16_sdwa v187, v187 dst_sel:WORD_1 dst_unused:UNUSED_PRESERVE src0_sel:WORD_1
  v_rcp_f16_sdwa v188, v188 dst_sel:WORD_1 dst_unused:UNUSED_PRESERVE src0_sel:WORD_1
  v_rcp_f16_sdwa v189, v189 dst_sel:WORD_1 dst_unused:UNUSED_PRESERVE src0_sel:WORD_1
  v_rcp_f16_sdwa v190, v190 dst_sel:WORD_1 dst_unused:UNUSED_PRESERVE src0_sel:WORD_1
  s_setprio 0
  s_waitcnt lgkmcnt(0)
  v_rcp_f16_sdwa v191, v191 dst_sel:WORD_1 dst_unused:UNUSED_PRESERVE src0_sel:WORD_1
  v_pk_mul_f16 v192, v176, v160
  v_pk_mul_f16 v193, v177, v161
  v_pk_add_f32 v[224:225], v[224:225], v[232:233] op_sel_hi:[1,0]
  v_pk_mul_f16 v194, v178, v162
  v_pk_add_f32 v[226:227], v[226:227], v[232:233] op_sel_hi:[1,0]
  v_pk_mul_f16 v195, v179, v163
  v_or_b32_sdwa v243, v251, v229 dst_sel:DWORD dst_unused:UNUSED_PAD src0_sel:DWORD src1_sel:BYTE_3
  v_pk_mul_f16 v196, v180, v164
  v_lshrrev_b32_e64 v228, 3, v228
  v_pk_mul_f16 v197, v181, v165
  v_and_b32 v229, 0xffffff, v229
  v_pk_mul_f16 v198, v182, v166
  v_pk_add_f32 v[248:249], v[248:249], s[52:53]
  v_pk_mul_f16 v199, v183, v167
  v_pk_mul_f16 v200, v184, v168
  v_pk_mul_f16 v201, v185, v169
  v_pk_mul_f16 v202, v186, v170
  v_pk_mul_f16 v203, v187, v171
  v_pk_mul_f16 v204, v188, v172
  v_pk_mul_f16 v205, v189, v173
  v_pk_mul_f16 v206, v190, v174
  v_pk_mul_f16 v207, v191, v175
  s_cbranch_scc0 K2_LOOP
K2_TAIL0:
  s_lshl_b32 s60, s30, 5
  s_sub_u32 s60, s21, s60
  s_add_u32 s60, s60, 32
  ds_write_b64 v250, v[246:247]
  v_cvt_pk_f16_f32 v160, v0, v1
  v_cvt_pk_f16_f32 v161, v2, v3
  v_cvt_pk_f16_f32 v168, v16, v17
  v_cvt_pk_f16_f32 v169, v18, v19
  v_exp_f16_sdwa v176, v160 dst_sel:WORD_0 dst_unused:UNUSED_PAD src0_sel:WORD_0
  v_mfma_f32_32x32x16_f16 v[64:79], v[216:219], v[192:195], v[64:79]
  v_exp_f16_sdwa v177, v161 dst_sel:WORD_0 dst_unused:UNUSED_PAD src0_sel:WORD_0
  v_exp_f16_sdwa v184, v168 dst_sel:WORD_0 dst_unused:UNUSED_PAD src0_sel:WORD_0
  v_mfma_f32_32x32x16_f16 v[80:95], v[216:219], v[200:203], v[80:95]
  v_exp_f16_sdwa v185, v169 dst_sel:WORD_0 dst_unused:UNUSED_PAD src0_sel:WORD_0
  v_exp_f16_sdwa v176, v160 dst_sel:WORD_1 dst_unused:UNUSED_PRESERVE src0_sel:WORD_1
  v_mfma_f32_32x32x16_f16 v[64:79], v[220:223], v[196:199], v[64:79]
  v_exp_f16_sdwa v177, v161 dst_sel:WORD_1 dst_unused:UNUSED_PRESERVE src0_sel:WORD_1
  v_exp_f16_sdwa v184, v168 dst_sel:WORD_1 dst_unused:UNUSED_PRESERVE src0_sel:WORD_1
  v_mfma_f32_32x32x16_f16 v[80:95], v[220:223], v[204:207], v[80:95]
  v_exp_f16_sdwa v185, v169 dst_sel:WORD_1 dst_unused:UNUSED_PRESERVE src0_sel:WORD_1
  s_cmp_eq_u32 s23, 0
  s_cbranch_scc1 K2_TNL_0
  v_lshlrev_b32 v46, 4, v252
  v_add_u32 v44, s27, v49
  v_add_u32 v45, s27, v50
  ds_read_b128 v[32:35], v238 offset:15392
  ds_read_b128 v[36:39], v238 offset:15456
  ds_read_b64 v[40:41], v44 offset:15392
  ds_read_b64 v[42:43], v45 offset:15904
  ds_read_b128 v[96:99], v46 offset:18432
  ds_read_b128 v[100:103], v46 offset:19456
  ds_read_b128 v[104:107], v46 offset:20480
  ds_read_b128 v[108:111], v46 offset:21504
  ds_read_b128 v[112:115], v46 offset:22528
  ds_read_b128 v[116:119], v46 offset:23552
  ds_read_b128 v[120:123], v46 offset:24576
  ds_read_b128 v[124:127], v46 offset:25600
  ds_read_b128 v[128:131], v46 offset:26624
  ds_read_b128 v[132:135], v46 offset:27648
  ds_read_b128 v[136:139], v46 offset:28672
  ds_read_b128 v[140:143], v46 offset:29696
  ds_read_b128 v[144:147], v46 offset:30720
  ds_read_b128 v[148:151], v46 offset:31744
  ds_read_b128 v[152:155], v46 offset:32768
  ds_read_b128 v[156:159], v46 offset:33792
K2_TNL_0:
  v_pk_add_f16 v176, v176, 1.0 op_sel_hi:[1,0]
  v_pk_add_f16 v177, v177, 1.0 op_sel_hi:[1,0]
  v_pk_add_f16 v184, v184, 1.0 op_sel_hi:[1,0]
  v_pk_add_f16 v185, v185, 1.0 op_sel_hi:[1,0]
  v_rcp_f16_sdwa v176, v176 dst_sel:WORD_0 dst_unused:UNUSED_PRESERVE src0_sel:WORD_0
  v_rcp_f16_sdwa v177, v177 dst_sel:WORD_0 dst_unused:UNUSED_PRESERVE src0_sel:WORD_0
  v_rcp_f16_sdwa v184, v184 dst_sel:WORD_0 dst_unused:UNUSED_PRESERVE src0_sel:WORD_0
  v_rcp_f16_sdwa v185, v185 dst_sel:WORD_0 dst_unused:UNUSED_PRESERVE src0_sel:WORD_0
  v_rcp_f16_sdwa v176, v176 dst_sel:WORD_1 dst_unused:UNUSED_PRESERVE src0_sel:WORD_1
  v_rcp_f16_sdwa v177, v177 dst_sel:WORD_1 dst_unused:UNUSED_PRESERVE src0_sel:WORD_1
  v_rcp_f16_sdwa v184, v184 dst_sel:WORD_1 dst_unused:UNUSED_PRESERVE src0_sel:WORD_1
  v_rcp_f16_sdwa v185, v185 dst_sel:WORD_1 dst_unused:UNUSED_PRESERVE src0_sel:WORD_1
  v_pk_mul_f16 v192, v176, v160
  v_pk_mul_f16 v193, v177, v161
  v_pk_mul_f16 v200, v184, v168
  v_pk_mul_f16 v201, v185, v169
  s_cmp_le_u32 s60, 8
  s_cbranch_scc1 K2_TEND_0
  v_cvt_pk_f16_f32 v162, v4, v5
  v_cvt_pk_f16_f32 v163, v6, v7
  v_cvt_pk_f16_f32 v170, v20, v21
  v_cvt_pk_f16_f32 v171, v22, v23
  v_exp_f16_sdwa v178, v162 dst_sel:WORD_0 dst_unused:UNUSED_PAD src0_sel:WORD_0
  v_exp_f16_sdwa v179, v163 dst_sel:WORD_0 dst_unused:UNUSED_PAD src0_sel:WORD_0
  v_exp_f16_sdwa v186, v170 dst_sel:WORD_0 dst_unused:UNUSED_PAD src0_sel:WORD_0
  v_exp_f16_sdwa v187, v171 dst_sel:WORD_0 dst_unused:UNUSED_PAD src0_sel:WORD_0
  v_exp_f16_sdwa v178, v162 dst_sel:WORD_1 dst_unused:UNUSED_PRESERVE src0_sel:WORD_1
  v_exp_f16_sdwa v179, v163 dst_sel:WORD_1 dst_unused:UNUSED_PRESERVE src0_sel:WORD_1
  v_exp_f16_sdwa v186, v170 dst_sel:WORD_1 dst_unused:UNUSED_PRESERVE src0_sel:WORD_1
  v_exp_f16_sdwa v187, v171 dst_sel:WORD_1 dst_unused:UNUSED_PRESERVE src0_sel:WORD_1
  v_pk_add_f16 v178, v178, 1.0 op_sel_hi:[1,0]
  v_pk_add_f16 v179, v179, 1.0 op_sel_hi:[1,0]
  v_pk_add_f16 v186, v186, 1.0 op_sel_hi:[1,0]
  v_pk_add_f16 v187, v187, 1.0 op_sel_hi:[1,0]
  v_rcp_f16_sdwa v178, v178 dst_sel:WORD_0 dst_unused:UNUSED_PRESERVE src0_sel:WORD_0
  v_rcp_f16_sdwa v179, v179 dst_sel:WORD_0 dst_unused:UNUSED_PRESERVE src0_sel:WORD_0
  v_rcp_f16_sdwa v186, v186 dst_sel:WORD_0 dst_unused:UNUSED_PRESERVE src0_sel:WORD_0
  v_rcp_f16_sdwa v187, v187 dst_sel:WORD_0 dst_unused:UNUSED_PRESERVE src0_sel:WORD_0
  v_rcp_f16_sdwa v178, v178 dst_sel:WORD_1 dst_unused:UNUSED_PRESERVE src0_sel:WORD_1
  v_rcp_f16_sdwa v179, v179 dst_sel:WORD_1 dst_unused:UNUSED_PRESERVE src0_sel:WORD_1
  v_rcp_f16_sdwa v186, v186 dst_sel:WORD_1 dst_unused:UNUSED_PRESERVE src0_sel:WORD_1
  v_rcp_f16_sdwa v187, v187 dst_sel:WORD_1 dst_unused:UNUSED_PRESERVE src0_sel:WORD_1
  v_pk_mul_f16 v194, v178, v162
  v_pk_mul_f16 v195, v179, v163
  v_pk_mul_f16 v202, v186, v170
  v_pk_mul_f16 v203, v187, v171
  s_cmp_le_u32 s60, 16
  s_cbranch_scc1 K2_TEND_0
  v_cvt_pk_f16_f32 v164, v8, v9
  v_cvt_pk_f16_f32 v165, v10, v11
  v_cvt_pk_f16_f32 v172, v24, v25
  v_cvt_pk_f16_f32 v173, v26, v27
  v_exp_f16_sdwa v180, v164 dst_sel:WORD_0 dst_unused:UNUSED_PAD src0_sel:WORD_0
  v_exp_f16_sdwa v181, v165 dst_sel:WORD_0 dst_unused:UNUSED_PAD src0_sel:WORD_0
  v_exp_f16_sdwa v188, v172 dst_sel:WORD_0 dst_unused:UNUSED_PAD src0_sel:WORD_0
  v_exp_f16_sdwa v189, v173 dst_sel:WORD_0 dst_unused:UNUSED_PAD src0_sel:WORD_0
  v_exp_f16_sdwa v180, v164 dst_sel:WORD_1 dst_unused:UNUSED_PRESERVE src0_sel:WORD_1
  v_exp_f16_sdwa v181, v165 dst_sel:WORD_1 dst_unused:UNUSED_PRESERVE src0_sel:WORD_1
  v_exp_f16_sdwa v188, v172 dst_sel:WORD_1 dst_unused:UNUSED_PRESERVE src0_sel:WORD_1
  v_exp_f16_sdwa v189, v173 dst_sel:WORD_1 dst_unused:UNUSED_PRESERVE src0_sel:WORD_1
  v_pk_add_f16 v180, v180, 1.0 op_sel_hi:[1,0]
  v_pk_add_f16 v181, v181, 1.0 op_sel_hi:[1,0]
  v_pk_add_f16 v188, v188, 1.0 op_sel_hi:[1,0]
  v_pk_add_f16 v189, v189, 1.0 op_sel_hi:[1,0]
  v_rcp_f16_sdwa v180, v180 dst_sel:WORD_0 dst_unused:UNUSED_PRESERVE src0_sel:WORD_0
  v_rcp_f16_sdwa v181, v181 dst_sel:WORD_0 dst_unused:UNUSED_PRESERVE src0_sel:WORD_0
  v_rcp_f16_sdwa v188, v188 dst_sel:WORD_0 dst_unused:UNUSED_PRESERVE src0_sel:WORD_0
  v_rcp_f16_sdwa v189, v189 dst_sel:WORD_0 dst_unused:UNUSED_PRESERVE src0_sel:WORD_0
  v_rcp_f16_sdwa v180, v180 dst_sel:WORD_1 dst_unused:UNUSED_PRESERVE src0_sel:WORD_1
  v_rcp_f16_sdwa v181, v181 dst_sel:WORD_1 dst_unused:UNUSED_PRESERVE src0_sel:WORD_1
  v_rcp_f16_sdwa v188, v188 dst_sel:WORD_1 dst_unused:UNUSED_PRESERVE src0_sel:WORD_1
  v_rcp_f16_sdwa v189, v189 dst_sel:WORD_1 dst_unused:UNUSED_PRESERVE src0_sel:WORD_1
  v_pk_mul_f16 v196, v180, v164
  v_pk_mul_f16 v197, v181, v165
  v_pk_mul_f16 v204, v188, v172
  v_pk_mul_f16 v205, v189, v173
  s_cmp_le_u32 s60, 24
  s_cbranch_scc1 K2_TEND_0
  v_cvt_pk_f16_f32 v166, v12, v13
  v_cvt_pk_f16_f32 v167, v14, v15
  v_cvt_pk_f16_f32 v174, v28, v29
  v_cvt_pk_f16_f32 v175, v30, v31
  v_exp_f16_sdwa v182, v166 dst_sel:WORD_0 dst_unused:UNUSED_PAD src0_sel:WORD_0
  v_exp_f16_sdwa v183, v167 dst_sel:WORD_0 dst_unused:UNUSED_PAD src0_sel:WORD_0
  v_exp_f16_sdwa v190, v174 dst_sel:WORD_0 dst_unused:UNUSED_PAD src0_sel:WORD_0
  v_exp_f16_sdwa v191, v175 dst_sel:WORD_0 dst_unused:UNUSED_PAD src0_sel:WORD_0
  v_exp_f16_sdwa v182, v166 dst_sel:WORD_1 dst_unused:UNUSED_PRESERVE src0_sel:WORD_1
  v_exp_f16_sdwa v183, v167 dst_sel:WORD_1 dst_unused:UNUSED_PRESERVE src0_sel:WORD_1
  v_exp_f16_sdwa v190, v174 dst_sel:WORD_1 dst_unused:UNUSED_PRESERVE src0_sel:WORD_1
  v_exp_f16_sdwa v191, v175 dst_sel:WORD_1 dst_unused:UNUSED_PRESERVE src0_sel:WORD_1
  v_pk_add_f16 v182, v182, 1.0 op_sel_hi:[1,0]
  v_pk_add_f16 v183, v183, 1.0 op_sel_hi:[1,0]
  v_pk_add_f16 v190, v190, 1.0 op_sel_hi:[1,0]
  v_pk_add_f16 v191, v191, 1.0 op_sel_hi:[1,0]
  v_rcp_f16_sdwa v182, v182 dst_sel:WORD_0 dst_unused:UNUSED_PRESERVE src0_sel:WORD_0
  v_rcp_f16_sdwa v183, v183 dst_sel:WORD_0 dst_unused:UNUSED_PRESERVE src0_sel:WORD_0
  v_rcp_f16_sdwa v190, v190 dst_sel:WORD_0 dst_unused:UNUSED_PRESERVE src0_sel:WORD_0
  v_rcp_f16_sdwa v191, v191 dst_sel:WORD_0 dst_unused:UNUSED_PRESERVE src0_sel:WORD_0
  v_rcp_f16_sdwa v182, v182 dst_sel:WORD_1 dst_unused:UNUSED_PRESERVE src0_sel:WORD_1
  v_rcp_f16_sdwa v183, v183 dst_sel:WORD_1 dst_unused:UNUSED_PRESERVE src0_sel:WORD_1
  v_rcp_f16_sdwa v190, v190 dst_sel:WORD_1 dst_unused:UNUSED_PRESERVE src0_sel:WORD_1
  v_rcp_f16_sdwa v191, v191 dst_sel:WORD_1 dst_unused:UNUSED_PRESERVE src0_sel:WORD_1
  v_pk_mul_f16 v198, v182, v166
  v_pk_mul_f16 v199, v183, v167
  v_pk_mul_f16 v206, v190, v174
  v_pk_mul_f16 v207, v191, v175
K2_TEND_0:
  s_nop 1
  v_mfma_f32_32x32x16_f16 v[64:79], v[208:211], v[192:195], v[64:79]
  v_mfma_f32_32x32x16_f16 v[80:95], v[208:211], v[200:203], v[80:95]
  v_mfma_f32_32x32x16_f16 v[64:79], v[212:215], v[196:199], v[64:79]
  v_mfma_f32_32x32x16_f16 v[80:95], v[212:215], v[204:207], v[80:95]
  s_cmp_eq_u32 s23, 0
  s_cbranch_scc1 K2_WEND
K2_EPI:
  s_setprio 0
  s_mov_b32 s60, 0xbf317218
  ds_read_b32 v199, v239 offset:128
  s_mul_i32 s61, s26, 30
  s_add_u32 s61, s61, 1279994
  s_mov_b32 s64, 0x20000
  s_mov_b32 s65, 0x20000
  s_waitcnt vmcnt(0) lgkmcnt(1)
  v_lshlrev_b32 v44, 16, v51
  v_and_b32 v45, 0xffff0000, v51
  v_mfma_f32_16x16x32_bf16 v[160:163], v[32:35], v[96:99], 0
  v_mfma_f32_16x16x32_bf16 v[164:167], v[32:35], v[100:103], 0
  v_mfma_f32_16x16x32_bf16 v[168:171], v[32:35], v[104:107], 0
  v_mfma_f32_16x16x32_bf16 v[172:175], v[32:35], v[108:111], 0
  v_mul_f32 v176, s60, v64
  v_mul_f32 v177, s60, v80
  v_cvt_pk_bf16_f32 v176, v176, v177
  ds_write_b32 v237, v176 offset:0
  v_mul_f32 v178, s60, v68
  v_mul_f32 v179, s60, v84
  v_cvt_pk_bf16_f32 v178, v178, v179
  ds_write_b32 v237, v178 offset:256
  v_mul_f32 v180, s60, v72
  v_mul_f32 v181, s60, v88
  v_cvt_pk_bf16_f32 v180, v180, v181
  ds_write_b32 v237, v180 offset:512
  ds_read_b128 v[208:211], v238 offset:128
  ds_read_b128 v[212:215], v238 offset:192
  v_mfma_f32_16x16x32_bf16 v[160:163], v[36:39], v[112:115], v[160:163]
  v_mfma_f32_16x16x32_bf16 v[164:167], v[36:39], v[116:119], v[164:167]
  v_mfma_f32_16x16x32_bf16 v[168:171], v[36:39], v[120:123], v[168:171]
  v_mfma_f32_16x16x32_bf16 v[172:175], v[36:39], v[124:127], v[172:175]
  v_mul_f32 v176, v65, v44
  v_mul_f32 v177, v66, v44
  v_mul_f32 v178, v67, v44
  v_mul_f32 v179, v69, v44
  v_mul_f32 v180, v70, v44
  v_mul_f32 v181, v71, v44
  v_mul_f32 v182, v73, v44
  v_mul_f32 v183, v74, v44
  v_mul_f32 v184, v75, v44
  v_cmp_class_f32 s[2:3], v64, s41
  v_cmp_class_f32 s[66:67], v80, s41
  v_fmac_f32 v176, v81, v45
  v_fmac_f32 v177, v82, v45
  v_fmac_f32 v178, v83, v45
  v_fmac_f32 v179, v85, v45
  v_fmac_f32 v180, v86, v45
  v_fmac_f32 v181, v87, v45
  v_fmac_f32 v182, v89, v45
  v_fmac_f32 v183, v90, v45
  v_fmac_f32 v184, v91, v45
  s_waitcnt lgkmcnt(0)
  v_mfma_f32_16x16x32_bf16 v[160:163], v[208:211], v[128:131], v[160:163]
  v_mfma_f32_16x16x32_bf16 v[164:167], v[208:211], v[132:135], v[164:167]
  v_mfma_f32_16x16x32_bf16 v[168:171], v[208:211], v[136:139], v[168:171]
  v_mfma_f32_16x16x32_bf16 v[172:175], v[208:211], v[140:143], v[172:175]
  v_mfma_f32_16x16x32_bf16 v[160:163], v[212:215], v[144:147], v[160:163]
  v_mfma_f32_16x16x32_bf16 v[164:167], v[212:215], v[148:151], v[164:167]
  v_mfma_f32_16x16x32_bf16 v[168:171], v[212:215], v[152:155], v[168:171]
  v_mfma_f32_16x16x32_bf16 v[172:175], v[212:215], v[156:159], v[172:175]
  s_or_b64 s[2:3], s[2:3], s[66:67]
  v_add_f32_dpp v176, v176, v176 row_mirror row_mask:0xf bank_mask:0x3
  v_add_f32_dpp v178, v178, v178 row_mirror row_mask:0xf bank_mask:0x3
  v_add_f32_dpp v180, v180, v180 row_mirror row_mask:0xf bank_mask:0x3
  v_add_f32_dpp v182, v182, v182 row_mirror row_mask:0xf bank_mask:0x3
  v_add_f32_dpp v184, v184, v184 row_mirror row_mask:0xf bank_mask:0xf
  v_add_f32_dpp v176, v177, v177 row_mirror row_mask:0xf bank_mask:0xc
  v_add_f32_dpp v178, v179, v179 row_mirror row_mask:0xf bank_mask:0xc
  v_add_f32_dpp v180, v181, v181 row_mirror row_mask:0xf bank_mask:0xc
  v_add_f32_dpp v182, v183, v183 row_mirror row_mask:0xf bank_mask:0xc
  v_add_f32_dpp v184, v184, v184 row_half_mirror row_mask:0xf bank_mask:0xf
  v_add_f32_dpp v176, v176, v176 row_half_mirror row_mask:0xf bank_mask:0x5
  v_add_f32_dpp v180, v180, v180 row_half_mirror row_mask:0xf bank_mask:0x5
  v_add_f32_dpp v184, v184, v184 quad_perm:[1,0,3,2] row_mask:0xf bank_mask:0xf
  v_add_f32_dpp v176, v178, v178 row_half_mirror row_mask:0xf bank_mask:0xa
  v_add_f32_dpp v180, v182, v182 row_half_mirror row_mask:0xf bank_mask:0xa
  v_add_f32_dpp v184, v184, v184 quad_perm:[2,3,0,1] row_mask:0xf bank_mask:0xf
  s_nop 0
  v_permlane16_swap_b32 v176, v180
  v_add_f32_dpp v184, v184, v184 row_bcast:15 row_mask:0xa bank_mask:0xf
  v_add_f32 v176, v176, v180
  s_nop 1
  v_add_f32_dpp v176, v176, v176 quad_perm:[1,0,3,2] row_mask:0xf bank_mask:0xf
  s_nop 1
  v_add_f32_dpp v176, v176, v176 quad_perm:[2,3,0,1] row_mask:0xf bank_mask:0xf
  s_mov_b64 exec, s[64:65]
  v_mov_b32 v176, v184
  s_mov_b32 exec_lo, 0x11131000
  s_mov_b32 exec_hi, 0x11131111
  v_fmac_f32 v199, s60, v176
  s_mov_b32 s60, 0xbfb8aa3b
  v_cmp_class_f32 vcc, v199, s41
  v_cvt_pk_bf16_f32 v199, v199, v199
  s_or_b64 vcc, vcc, s[2:3]
  s_and_b64 vcc, vcc, s[36:37]
  s_cbranch_scc1 K2_SAFE
  buffer_store_short v199, v48, s[48:51], s61 offen
  s_mov_b64 exec, -1
  v_mul_f32 v176, s60, v160
  v_mul_f32 v177, s60, v164
  v_mul_f32 v178, s60, v168
  v_mul_f32 v179, s60, v172
  v_mul_f32 v180, s60, v161
  v_mul_f32 v181, s60, v165
  v_mul_f32 v182, s60, v169
  v_mul_f32 v183, s60, v173
  v_exp_f32 v176, v176
  v_exp_f32 v177, v177
  v_exp_f32 v178, v178
  v_exp_f32 v179, v179
  v_exp_f32 v180, v180
  v_exp_f32 v181, v181
  v_exp_f32 v182, v182
  v_exp_f32 v183, v183
  v_lshlrev_b32 v200, 16, v40
  v_and_b32 v201, 0xffff0000, v40
  v_lshlrev_b32 v202, 16, v41
  v_and_b32 v203, 0xffff0000, v41
  v_lshlrev_b32 v204, 16, v42
  v_and_b32 v205, 0xffff0000, v42
  v_lshlrev_b32 v206, 16, v43
  v_and_b32 v207, 0xffff0000, v43
  v_add_f32 v176, 1.0, v176
  v_add_f32 v177, 1.0, v177
  v_add_f32 v178, 1.0, v178
  v_add_f32 v179, 1.0, v179
  v_add_f32 v180, 1.0, v180
  v_add_f32 v181, 1.0, v181
  v_add_f32 v182, 1.0, v182
  v_add_f32 v183, 1.0, v183
  v_rcp_f32 v176, v176
  v_rcp_f32 v177, v177
  v_rcp_f32 v178, v178
  v_rcp_f32 v179, v179
  v_rcp_f32 v180, v180
  v_rcp_f32 v181, v181
  v_rcp_f32 v182, v182
  v_rcp_f32 v183, v183
  s_nop 0
  v_fmac_f32 v200, v160, v176
  v_fmac_f32 v201, v164, v177
  v_fmac_f32 v202, v168, v178
  v_fmac_f32 v203, v172, v179
  v_fmac_f32 v204, v161, v180
  v_fmac_f32 v205, v165, v181
  v_fmac_f32 v206, v169, v182
  v_fmac_f32 v207, v173, v183
  v_cvt_pk_bf16_f32 v40, v200, v201
  v_cvt_pk_bf16_f32 v41, v202, v203
  v_cvt_pk_bf16_f32 v42, v204, v205
  v_cvt_pk_bf16_f32 v43, v206, v207
  buffer_store_dwordx2 v[40:41], v49, s[48:51], s40 offen
  s_mov_b64 exec, 0xffff
  buffer_store_dwordx2 v[42:43], v50, s[48:51], s40 offen offset:512
  s_endpgm
K2_TAIL1:
  s_lshl_b32 s60, s30, 5
  s_sub_u32 s60, s21, s60
  s_add_u32 s60, s60, 32
  v_cvt_pk_f16_f32 v160, v0, v1
  v_cvt_pk_f16_f32 v161, v2, v3
  v_cvt_pk_f16_f32 v168, v16, v17
  v_cvt_pk_f16_f32 v169, v18, v19
  v_exp_f16_sdwa v176, v160 dst_sel:WORD_0 dst_unused:UNUSED_PAD src0_sel:WORD_0
  v_mfma_f32_32x32x16_f16 v[64:79], v[208:211], v[192:195], v[64:79]
  v_exp_f16_sdwa v177, v161 dst_sel:WORD_0 dst_unused:UNUSED_PAD src0_sel:WORD_0
  v_exp_f16_sdwa v184, v168 dst_sel:WORD_0 dst_unused:UNUSED_PAD src0_sel:WORD_0
  v_mfma_f32_32x32x16_f16 v[80:95], v[208:211], v[200:203], v[80:95]
  v_exp_f16_sdwa v185, v169 dst_sel:WORD_0 dst_unused:UNUSED_PAD src0_sel:WORD_0
  v_exp_f16_sdwa v176, v160 dst_sel:WORD_1 dst_unused:UNUSED_PRESERVE src0_sel:WORD_1
  v_mfma_f32_32x32x16_f16 v[64:79], v[212:215], v[196:199], v[64:79]
  v_exp_f16_sdwa v177, v161 dst_sel:WORD_1 dst_unused:UNUSED_PRESERVE src0_sel:WORD_1
  v_exp_f16_sdwa v184, v168 dst_sel:WORD_1 dst_unused:UNUSED_PRESERVE src0_sel:WORD_1
  v_mfma_f32_32x32x16_f16 v[80:95], v[212:215], v[204:207], v[80:95]
  v_exp_f16_sdwa v185, v169 dst_sel:WORD_1 dst_unused:UNUSED_PRESERVE src0_sel:WORD_1
  s_cmp_eq_u32 s23, 0
  s_cbranch_scc1 K2_TNL_1
  v_lshlrev_b32 v46, 4, v252
  v_add_u32 v44, s27, v49
  v_add_u32 v45, s27, v50
  ds_read_b128 v[32:35], v238 offset:15392
  ds_read_b128 v[36:39], v238 offset:15456
  ds_read_b64 v[40:41], v44 offset:15392
  ds_read_b64 v[42:43], v45 offset:15904
  ds_read_b128 v[96:99], v46 offset:18432
  ds_read_b128 v[100:103], v46 offset:19456
  ds_read_b128 v[104:107], v46 offset:20480
  ds_read_b128 v[108:111], v46 offset:21504
  ds_read_b128 v[112:115], v46 offset:22528
  ds_read_b128 v[116:119], v46 offset:23552
  ds_read_b128 v[120:123], v46 offset:24576
  ds_read_b128 v[124:127], v46 offset:25600
  ds_read_b128 v[128:131], v46 offset:26624
  ds_read_b128 v[132:135], v46 offset:27648
  ds_read_b128 v[136:139], v46 offset:28672
  ds_read_b128 v[140:143], v46 offset:29696
  ds_read_b128 v[144:147], v46 offset:30720
  ds_read_b128 v[148:151], v46 offset:31744
  ds_read_b128 v[152:155], v46 offset:32768
  ds_read_b128 v[156:159], v46 offset:33792
K2_TNL_1:
  v_pk_add_f16 v176, v176, 1.0 op_sel_hi:[1,0]
  v_pk_add_f16 v177, v177, 1.0 op_sel_hi:[1,0]
  v_pk_add_f16 v184, v184, 1.0 op_sel_hi:[1,0]
  v_pk_add_f16 v185, v185, 1.0 op_sel_hi:[1,0]
  v_rcp_f16_sdwa v176, v176 dst_sel:WORD_0 dst_unused:UNUSED_PRESERVE src0_sel:WORD_0
  v_rcp_f16_sdwa v177, v177 dst_sel:WORD_0 dst_unused:UNUSED_PRESERVE src0_sel:WORD_0
  v_rcp_f16_sdwa v184, v184 dst_sel:WORD_0 dst_unused:UNUSED_PRESERVE src0_sel:WORD_0
  v_rcp_f16_sdwa v185, v185 dst_sel:WORD_0 dst_unused:UNUSED_PRESERVE src0_sel:WORD_0
  v_rcp_f16_sdwa v176, v176 dst_sel:WORD_1 dst_unused:UNUSED_PRESERVE src0_sel:WORD_1
  v_rcp_f16_sdwa v177, v177 dst_sel:WORD_1 dst_unused:UNUSED_PRESERVE src0_sel:WORD_1
  v_rcp_f16_sdwa v184, v184 dst_sel:WORD_1 dst_unused:UNUSED_PRESERVE src0_sel:WORD_1
  v_rcp_f16_sdwa v185, v185 dst_sel:WORD_1 dst_unused:UNUSED_PRESERVE src0_sel:WORD_1
  v_pk_mul_f16 v192, v176, v160
  v_pk_mul_f16 v193, v177, v161
  v_pk_mul_f16 v200, v184, v168
  v_pk_mul_f16 v201, v185, v169
  s_cmp_le_u32 s60, 8
  s_cbranch_scc1 K2_TEND_1
  v_cvt_pk_f16_f32 v162, v4, v5
  v_cvt_pk_f16_f32 v163, v6, v7
  v_cvt_pk_f16_f32 v170, v20, v21
  v_cvt_pk_f16_f32 v171, v22, v23
  v_exp_f16_sdwa v178, v162 dst_sel:WORD_0 dst_unused:UNUSED_PAD src0_sel:WORD_0
  v_exp_f16_sdwa v179, v163 dst_sel:WORD_0 dst_unused:UNUSED_PAD src0_sel:WORD_0
  v_exp_f16_sdwa v186, v170 dst_sel:WORD_0 dst_unused:UNUSED_PAD src0_sel:WORD_0
  v_exp_f16_sdwa v187, v171 dst_sel:WORD_0 dst_unused:UNUSED_PAD src0_sel:WORD_0
  v_exp_f16_sdwa v178, v162 dst_sel:WORD_1 dst_unused:UNUSED_PRESERVE src0_sel:WORD_1
  v_exp_f16_sdwa v179, v163 dst_sel:WORD_1 dst_unused:UNUSED_PRESERVE src0_sel:WORD_1
  v_exp_f16_sdwa v186, v170 dst_sel:WORD_1 dst_unused:UNUSED_PRESERVE src0_sel:WORD_1
  v_exp_f16_sdwa v187, v171 dst_sel:WORD_1 dst_unused:UNUSED_PRESERVE src0_sel:WORD_1
  v_pk_add_f16 v178, v178, 1.0 op_sel_hi:[1,0]
  v_pk_add_f16 v179, v179, 1.0 op_sel_hi:[1,0]
  v_pk_add_f16 v186, v186, 1.0 op_sel_hi:[1,0]
  v_pk_add_f16 v187, v187, 1.0 op_sel_hi:[1,0]
  v_rcp_f16_sdwa v178, v178 dst_sel:WORD_0 dst_unused:UNUSED_PRESERVE src0_sel:WORD_0
  v_rcp_f16_sdwa v179, v179 dst_sel:WORD_0 dst_unused:UNUSED_PRESERVE src0_sel:WORD_0
  v_rcp_f16_sdwa v186, v186 dst_sel:WORD_0 dst_unused:UNUSED_PRESERVE src0_sel:WORD_0
  v_rcp_f16_sdwa v187, v187 dst_sel:WORD_0 dst_unused:UNUSED_PRESERVE src0_sel:WORD_0
  v_rcp_f16_sdwa v178, v178 dst_sel:WORD_1 dst_unused:UNUSED_PRESERVE src0_sel:WORD_1
  v_rcp_f16_sdwa v179, v179 dst_sel:WORD_1 dst_unused:UNUSED_PRESERVE src0_sel:WORD_1
  v_rcp_f16_sdwa v186, v186 dst_sel:WORD_1 dst_unused:UNUSED_PRESERVE src0_sel:WORD_1
  v_rcp_f16_sdwa v187, v187 dst_sel:WORD_1 dst_unused:UNUSED_PRESERVE src0_sel:WORD_1
  v_pk_mul_f16 v194, v178, v162
  v_pk_mul_f16 v195, v179, v163
  v_pk_mul_f16 v202, v186, v170
  v_pk_mul_f16 v203, v187, v171
  s_cmp_le_u32 s60, 16
  s_cbranch_scc1 K2_TEND_1
  v_cvt_pk_f16_f32 v164, v8, v9
  v_cvt_pk_f16_f32 v165, v10, v11
  v_cvt_pk_f16_f32 v172, v24, v25
  v_cvt_pk_f16_f32 v173, v26, v27
  v_exp_f16_sdwa v180, v164 dst_sel:WORD_0 dst_unused:UNUSED_PAD src0_sel:WORD_0
  v_exp_f16_sdwa v181, v165 dst_sel:WORD_0 dst_unused:UNUSED_PAD src0_sel:WORD_0
  v_exp_f16_sdwa v188, v172 dst_sel:WORD_0 dst_unused:UNUSED_PAD src0_sel:WORD_0
  v_exp_f16_sdwa v189, v173 dst_sel:WORD_0 dst_unused:UNUSED_PAD src0_sel:WORD_0
  v_exp_f16_sdwa v180, v164 dst_sel:WORD_1 dst_unused:UNUSED_PRESERVE src0_sel:WORD_1
  v_exp_f16_sdwa v181, v165 dst_sel:WORD_1 dst_unused:UNUSED_PRESERVE src0_sel:WORD_1
  v_exp_f16_sdwa v188, v172 dst_sel:WORD_1 dst_unused:UNUSED_PRESERVE src0_sel:WORD_1
  v_exp_f16_sdwa v189, v173 dst_sel:WORD_1 dst_unused:UNUSED_PRESERVE src0_sel:WORD_1
  v_pk_add_f16 v180, v180, 1.0 op_sel_hi:[1,0]
  v_pk_add_f16 v181, v181, 1.0 op_sel_hi:[1,0]
  v_pk_add_f16 v188, v188, 1.0 op_sel_hi:[1,0]
  v_pk_add_f16 v189, v189, 1.0 op_sel_hi:[1,0]
  v_rcp_f16_sdwa v180, v180 dst_sel:WORD_0 dst_unused:UNUSED_PRESERVE src0_sel:WORD_0
  v_rcp_f16_sdwa v181, v181 dst_sel:WORD_0 dst_unused:UNUSED_PRESERVE src0_sel:WORD_0
  v_rcp_f16_sdwa v188, v188 dst_sel:WORD_0 dst_unused:UNUSED_PRESERVE src0_sel:WORD_0
  v_rcp_f16_sdwa v189, v189 dst_sel:WORD_0 dst_unused:UNUSED_PRESERVE src0_sel:WORD_0
  v_rcp_f16_sdwa v180, v180 dst_sel:WORD_1 dst_unused:UNUSED_PRESERVE src0_sel:WORD_1
  v_rcp_f16_sdwa v181, v181 dst_sel:WORD_1 dst_unused:UNUSED_PRESERVE src0_sel:WORD_1
  v_rcp_f16_sdwa v188, v188 dst_sel:WORD_1 dst_unused:UNUSED_PRESERVE src0_sel:WORD_1
  v_rcp_f16_sdwa v189, v189 dst_sel:WORD_1 dst_unused:UNUSED_PRESERVE src0_sel:WORD_1
  v_pk_mul_f16 v196, v180, v164
  v_pk_mul_f16 v197, v181, v165
  v_pk_mul_f16 v204, v188, v172
  v_pk_mul_f16 v205, v189, v173
  s_cmp_le_u32 s60, 24
  s_cbranch_scc1 K2_TEND_1
  v_cvt_pk_f16_f32 v166, v12, v13
  v_cvt_pk_f16_f32 v167, v14, v15
  v_cvt_pk_f16_f32 v174, v28, v29
  v_cvt_pk_f16_f32 v175, v30, v31
  v_exp_f16_sdwa v182, v166 dst_sel:WORD_0 dst_unused:UNUSED_PAD src0_sel:WORD_0
  v_exp_f16_sdwa v183, v167 dst_sel:WORD_0 dst_unused:UNUSED_PAD src0_sel:WORD_0
  v_exp_f16_sdwa v190, v174 dst_sel:WORD_0 dst_unused:UNUSED_PAD src0_sel:WORD_0
  v_exp_f16_sdwa v191, v175 dst_sel:WORD_0 dst_unused:UNUSED_PAD src0_sel:WORD_0
  v_exp_f16_sdwa v182, v166 dst_sel:WORD_1 dst_unused:UNUSED_PRESERVE src0_sel:WORD_1
  v_exp_f16_sdwa v183, v167 dst_sel:WORD_1 dst_unused:UNUSED_PRESERVE src0_sel:WORD_1
  v_exp_f16_sdwa v190, v174 dst_sel:WORD_1 dst_unused:UNUSED_PRESERVE src0_sel:WORD_1
  v_exp_f16_sdwa v191, v175 dst_sel:WORD_1 dst_unused:UNUSED_PRESERVE src0_sel:WORD_1
  v_pk_add_f16 v182, v182, 1.0 op_sel_hi:[1,0]
  v_pk_add_f16 v183, v183, 1.0 op_sel_hi:[1,0]
  v_pk_add_f16 v190, v190, 1.0 op_sel_hi:[1,0]
  v_pk_add_f16 v191, v191, 1.0 op_sel_hi:[1,0]
  v_rcp_f16_sdwa v182, v182 dst_sel:WORD_0 dst_unused:UNUSED_PRESERVE src0_sel:WORD_0
  v_rcp_f16_sdwa v183, v183 dst_sel:WORD_0 dst_unused:UNUSED_PRESERVE src0_sel:WORD_0
  v_rcp_f16_sdwa v190, v190 dst_sel:WORD_0 dst_unused:UNUSED_PRESERVE src0_sel:WORD_0
  v_rcp_f16_sdwa v191, v191 dst_sel:WORD_0 dst_unused:UNUSED_PRESERVE src0_sel:WORD_0
  v_rcp_f16_sdwa v182, v182 dst_sel:WORD_1 dst_unused:UNUSED_PRESERVE src0_sel:WORD_1
  v_rcp_f16_sdwa v183, v183 dst_sel:WORD_1 dst_unused:UNUSED_PRESERVE src0_sel:WORD_1
  v_rcp_f16_sdwa v190, v190 dst_sel:WORD_1 dst_unused:UNUSED_PRESERVE src0_sel:WORD_1
  v_rcp_f16_sdwa v191, v191 dst_sel:WORD_1 dst_unused:UNUSED_PRESERVE src0_sel:WORD_1
  v_pk_mul_f16 v198, v182, v166
  v_pk_mul_f16 v199, v183, v167
  v_pk_mul_f16 v206, v190, v174
  v_pk_mul_f16 v207, v191, v175
K2_TEND_1:
  s_nop 1
  v_mfma_f32_32x32x16_f16 v[64:79], v[216:219], v[192:195], v[64:79]
  v_mfma_f32_32x32x16_f16 v[80:95], v[216:219], v[200:203], v[80:95]
  v_mfma_f32_32x32x16_f16 v[64:79], v[220:223], v[196:199], v[64:79]
  v_mfma_f32_32x32x16_f16 v[80:95], v[220:223], v[204:207], v[80:95]
  s_cmp_eq_u32 s23, 0
  s_cbranch_scc1 K2_WEND
  s_branch K2_EPI
K2_NF:
  s_cmp_lg_u32 s36, 0
  s_cbranch_scc1 K2_NFR
  s_waitcnt vmcnt(10)
  ds_read_b128 v[228:231], v243 offset:128
  ds_read_b128 v[132:135], v243
  ds_read_b128 v[224:227], v248 offset:256
  ds_read2st64_b32 v[140:141], v249 offset0:1 offset1:9
  ds_read_b128 v[144:147], v248 offset:384
  s_waitcnt vmcnt(4)
  ds_read_b64_tr_b16 v[112:113], v233 offset:0
  ds_read_b64_tr_b16 v[114:115], v233 offset:1024
  ds_read_b64_tr_b16 v[120:121], v234 offset:0
  ds_read_b64_tr_b16 v[122:123], v234 offset:1024
  ds_read_b64_tr_b16 v[116:117], v233 offset:2048
  ds_read_b64_tr_b16 v[118:119], v233 offset:3072
  ds_read_b64_tr_b16 v[124:125], v234 offset:2048
  ds_read_b64_tr_b16 v[126:127], v234 offset:3072
  s_waitcnt lgkmcnt(11)
  v_pk_add_f32 v[228:229], v[228:229], v[240:241] neg_lo:[0,1] neg_hi:[0,1]
  v_sub_f32 v230, v230, v242
  v_add_u32 v250, v235, v243
  v_mul_f32 v253, v228, v228
  v_fmac_f32 v253, v229, v229
  v_fmac_f32 v253, v230, v230
  v_cvt_pk_bf16_f32 v130, v253, v253
  v_cvt_pk_bf16_f32 v244, 1.0, v228
  v_cvt_pk_bf16_f32 v245, v229, v230
  ds_write_b64 v250, v[244:245]
  v_permlane32_swap_b32 v128, v132
  v_permlane32_swap_b32 v129, v133
  v_permlane32_swap_b32 v130, v134
  ds_read_b64_tr_b16 v[208:209], v236 offset:0
  ds_read_b64_tr_b16 v[210:211], v236 offset:384
  ds_read_b64_tr_b16 v[212:213], v236 offset:768
  ds_read_b64_tr_b16 v[214:215], v236 offset:1152
  s_waitcnt lgkmcnt(13)
  v_pk_add_f32 v[224:225], v[224:225], v[232:233] op_sel_hi:[1,0]
  v_pk_add_f32 v[226:227], v[226:227], v[232:233] op_sel_hi:[1,0]
  s_mov_b32 m0, s0
  s_waitcnt lgkmcnt(11)
  v_mfma_f32_32x32x16_bf16 v[0:15], v[96:99], v[112:115], 0
  s_waitcnt lgkmcnt(9)
  v_mfma_f32_32x32x16_bf16 v[16:31], v[96:99], v[120:123], 0
  s_waitcnt lgkmcnt(7)
  v_mfma_f32_32x32x16_bf16 v[0:15], v[100:103], v[116:119], v[0:15]
  s_waitcnt lgkmcnt(5)
  v_mfma_f32_32x32x16_bf16 v[16:31], v[100:103], v[124:127], v[16:31]
  v_mfma_f32_32x32x16_bf16 v[0:15], v[128:131], v[104:107], v[0:15]
  v_mfma_f32_32x32x16_bf16 v[16:31], v[128:131], v[108:111], v[16:31]
  v_mov_b32 v228, v140
  v_mov_b32 v229, v141
  buffer_load_dwordx4 v224, s[32:35], s4 offen offset:0 lds
  buffer_load_dwordx4 v225, s[32:35], s5 offen offset:1024 lds
  buffer_load_dwordx4 v226, s[32:35], s6 offen offset:2048 lds
  buffer_load_dwordx4 v227, s[32:35], s7 offen offset:3072 lds
  v_pk_add_f32 v[224:225], v[144:145], v[232:233] op_sel_hi:[1,0]
  v_pk_add_f32 v[226:227], v[146:147], v[232:233] op_sel_hi:[1,0]
  v_or_b32_sdwa v243, v251, v229 dst_sel:DWORD dst_unused:UNUSED_PAD src0_sel:DWORD src1_sel:BYTE_3
  v_lshrrev_b32 v228, 3, v228
  v_and_b32 v229, 0xffffff, v229
  s_sub_u32 s31, s30, 2
  s_setprio 0
  s_nop 2
  s_waitcnt lgkmcnt(0)
  s_cbranch_scc1 K2_TAIL0S
K2_LOOPS:
  s_nop 0
  s_waitcnt vmcnt(4)
  s_nop 0
  ds_read_b64_tr_b16 v[112:113], v233 offset:4096
  s_nop 0
  ds_read_b64_tr_b16 v[114:115], v233 offset:5120
  s_nop 0
  ds_read_b64_tr_b16 v[120:121], v234 offset:4096
  s_nop 0
  ds_read_b64_tr_b16 v[122:123], v234 offset:5120
  s_nop 0
  v_mfma_f32_32x32x16_bf16 v[64:79], v[216:219], v[192:195], v[64:79]
  s_nop 0
  ds_read_b64_tr_b16 v[116:117], v233 offset:6144
  s_nop 0
  ds_read_b64_tr_b16 v[118:119], v233 offset:7168
  s_nop 0
  ds_read_b64_tr_b16 v[124:125], v234 offset:6144
  s_nop 0
  ds_read_b64_tr_b16 v[126:127], v234 offset:7168
  s_nop 0
  s_mov_b32 m0, s1
  s_nop 0
  buffer_load_dwordx2 v[128:129], v229, s[32:35], s8 offen
  s_nop 0
  buffer_load_dwordx3 v[240:242], v228, s[32:35], s17 offen
  s_nop 0
  v_mfma_f32_32x32x16_bf16 v[80:95], v[216:219], v[200:203], v[80:95]
  s_nop 0
  s_nop 0
  v_exp_f32 v160, v0
  v_exp_f32 v161, v1
  v_exp_f32 v162, v2
  v_mfma_f32_32x32x16_bf16 v[64:79], v[220:223], v[196:199], v[64:79]
  v_exp_f32 v163, v3
  v_exp_f32 v164, v4
  v_exp_f32 v165, v5
  v_exp_f32 v166, v6
  v_exp_f32 v167, v7
  v_exp_f32 v168, v8
  v_mfma_f32_32x32x16_bf16 v[80:95], v[220:223], v[204:207], v[80:95]
  v_exp_f32 v169, v9
  v_exp_f32 v170, v10
  s_waitcnt lgkmcnt(0)
  v_exp_f32 v171, v11
  v_exp_f32 v172, v12
  v_mfma_f32_32x32x16_bf16 v[32:47], v[96:99], v[112:115], 0
  v_exp_f32 v173, v13
  buffer_load_dwordx4 v224, s[32:35], s4 offen offset:0 lds
  v_exp_f32 v174, v14
  buffer_load_dwordx4 v225, s[32:35], s5 offen offset:1024 lds
  v_exp_f32 v175, v15
  buffer_load_dwordx4 v226, s[32:35], s6 offen offset:2048 lds
  v_exp_f32 v176, v16
  buffer_load_dwordx4 v227, s[32:35], s7 offen offset:3072 lds
  v_exp_f32 v177, v17
  v_exp_f32 v178, v18
  v_exp_f32 v179, v19
  v_mfma_f32_32x32x16_bf16 v[48:63], v[96:99], v[120:123], 0
  v_exp_f32 v180, v20
  ds_read_b64_tr_b16 v[216:217], v236 offset:1536
  v_exp_f32 v181, v21
  ds_read_b64_tr_b16 v[218:219], v236 offset:1920
  v_exp_f32 v182, v22
  ds_read_b64_tr_b16 v[220:221], v236 offset:2304
  v_exp_f32 v183, v23
  ds_read_b64_tr_b16 v[222:223], v236 offset:2688
  v_exp_f32 v184, v24
  ds_write_b64 v250, v[246:247]
  v_exp_f32 v185, v25
  v_exp_f32 v186, v26
  v_mfma_f32_32x32x16_bf16 v[32:47], v[100:103], v[116:119], v[32:47]
  v_exp_f32 v187, v27
  v_exp_f32 v188, v28
  v_exp_f32 v189, v29
  v_exp_f32 v190, v30
  v_exp_f32 v191, v31
  v_add_f32 v160, 1.0, v160
  v_add_f32 v161, 1.0, v161
  v_add_f32 v162, 1.0, v162
  v_add_f32 v163, 1.0, v163
  v_add_f32 v164, 1.0, v164
  v_add_f32 v165, 1.0, v165
  v_add_f32 v166, 1.0, v166
  v_add_f32 v167, 1.0, v167
  v_add_f32 v168, 1.0, v168
  v_add_f32 v169, 1.0, v169
  v_add_f32 v170, 1.0, v170
  v_add_f32 v171, 1.0, v171
  v_add_f32 v172, 1.0, v172
  v_add_f32 v173, 1.0, v173
  v_add_f32 v174, 1.0, v174
  v_add_f32 v175, 1.0, v175
  v_add_f32 v176, 1.0, v176
  v_add_f32 v177, 1.0, v177
  v_add_f32 v178, 1.0, v178
  v_add_f32 v179, 1.0, v179
  v_add_f32 v180, 1.0, v180
  v_add_f32 v181, 1.0, v181
  v_add_f32 v182, 1.0, v182
  v_add_f32 v183, 1.0, v183
  v_add_f32 v184, 1.0, v184
  v_add_f32 v185, 1.0, v185
  v_add_f32 v186, 1.0, v186
  v_add_f32 v187, 1.0, v187
  v_add_f32 v188, 1.0, v188
  v_add_f32 v189, 1.0, v189
  v_add_f32 v190, 1.0, v190
  v_add_f32 v191, 1.0, v191
  v_rcp_f32 v160, v160
  v_rcp_f32 v161, v161
  v_mfma_f32_32x32x16_bf16 v[48:63], v[100:103], v[124:127], v[48:63]
  v_rcp_f32 v162, v162
  v_rcp_f32 v163, v163
  ds_read_b128 v[224:227], v248 offset:512
  v_rcp_f32 v164, v164
  v_rcp_f32 v165, v165
  v_rcp_f32 v166, v166
  v_rcp_f32 v167, v167
  v_rcp_f32 v168, v168
  v_rcp_f32 v169, v169
  v_rcp_f32 v170, v170
  v_mfma_f32_32x32x16_bf16 v[32:47], v[132:135], v[104:107], v[32:47]
  v_rcp_f32 v171, v171
  v_rcp_f32 v172, v172
  v_rcp_f32 v173, v173
  v_rcp_f32 v174, v174
  v_rcp_f32 v175, v175
  v_rcp_f32 v176, v176
  v_rcp_f32 v177, v177
  v_rcp_f32 v178, v178
  v_rcp_f32 v179, v179
  v_mfma_f32_32x32x16_bf16 v[48:63], v[132:135], v[108:111], v[48:63]
  v_rcp_f32 v180, v180
  v_rcp_f32 v181, v181
  v_rcp_f32 v182, v182
  v_rcp_f32 v183, v183
  v_rcp_f32 v184, v184
  v_rcp_f32 v185, v185
  v_rcp_f32 v186, v186
  v_rcp_f32 v187, v187
  v_rcp_f32 v188, v188
  s_sub_u32 s31, s31, 1
  v_rcp_f32 v189, v189
  v_rcp_f32 v190, v190
  s_waitcnt lgkmcnt(0)
  v_rcp_f32 v191, v191
  v_mul_f32 v160, v160, v0
  v_mul_f32 v161, v161, v1
  v_pk_add_f32 v[224:225], v[224:225], v[232:233] op_sel_hi:[1,0]
  v_mul_f32 v162, v162, v2
  v_pk_add_f32 v[226:227], v[226:227], v[232:233] op_sel_hi:[1,0]
  v_mul_f32 v163, v163, v3
  v_mul_f32 v164, v164, v4
  v_mul_f32 v165, v165, v5
  v_mul_f32 v166, v166, v6
  v_mul_f32 v167, v167, v7
  v_mul_f32 v168, v168, v8
  v_mul_f32 v169, v169, v9
  v_mul_f32 v170, v170, v10
  v_mul_f32 v171, v171, v11
  v_mul_f32 v172, v172, v12
  v_mul_f32 v173, v173, v13
  v_mul_f32 v174, v174, v14
  v_mul_f32 v175, v175, v15
  v_mul_f32 v176, v176, v16
  v_mul_f32 v177, v177, v17
  v_mul_f32 v178, v178, v18
  v_mul_f32 v179, v179, v19
  v_mul_f32 v180, v180, v20
  v_mul_f32 v181, v181, v21
  v_mul_f32 v182, v182, v22
  v_mul_f32 v183, v183, v23
  v_mul_f32 v184, v184, v24
  v_mul_f32 v185, v185, v25
  v_mul_f32 v186, v186, v26
  v_mul_f32 v187, v187, v27
  v_mul_f32 v188, v188, v28
  v_mul_f32 v189, v189, v29
  v_mul_f32 v190, v190, v30
  v_mul_f32 v191, v191, v31
  v_cvt_pk_bf16_f32 v192, v160, v161
  v_cvt_pk_bf16_f32 v193, v162, v163
  v_cvt_pk_bf16_f32 v194, v164, v165
  v_cvt_pk_bf16_f32 v195, v166, v167
  v_cvt_pk_bf16_f32 v196, v168, v169
  v_cvt_pk_bf16_f32 v197, v170, v171
  v_cvt_pk_bf16_f32 v198, v172, v173
  v_cvt_pk_bf16_f32 v199, v174, v175
  v_cvt_pk_bf16_f32 v200, v176, v177
  v_cvt_pk_bf16_f32 v201, v178, v179
  v_cvt_pk_bf16_f32 v202, v180, v181
  v_cvt_pk_bf16_f32 v203, v182, v183
  v_cvt_pk_bf16_f32 v204, v184, v185
  v_cvt_pk_bf16_f32 v205, v186, v187
  v_cvt_pk_bf16_f32 v206, v188, v189
  v_cvt_pk_bf16_f32 v207, v190, v191
  s_cbranch_scc1 K2_TAIL1S
  s_nop 0
  s_waitcnt vmcnt(6)
  s_nop 0
  ds_read_b64_tr_b16 v[112:113], v233 offset:0
  s_nop 0
  ds_read_b64_tr_b16 v[114:115], v233 offset:1024
  s_nop 0
  ds_read_b64_tr_b16 v[120:121], v234 offset:0
  s_nop 0
  ds_read_b64_tr_b16 v[122:123], v234 offset:1024
  s_nop 0
  v_mfma_f32_32x32x16_bf16 v[64:79], v[208:211], v[192:195], v[64:79]
  s_nop 0
  ds_read_b64_tr_b16 v[116:117], v233 offset:2048
  s_nop 0
  ds_read_b64_tr_b16 v[118:119], v233 offset:3072
  s_nop 0
  ds_read_b64_tr_b16 v[124:125], v234 offset:2048
  s_nop 0
  ds_read_b64_tr_b16 v[126:127], v234 offset:3072
  s_nop 0
  s_mov_b32 m0, s0
  s_nop 0
  ds_read_b128 v[228:231], v243 offset:128
  s_nop 0
  ds_read_b128 v[132:135], v243
  s_nop 0
  v_mfma_f32_32x32x16_bf16 v[80:95], v[208:211], v[200:203], v[80:95]
  s_nop 0
  s_nop 0
  v_exp_f32 v160, v32
  v_exp_f32 v161, v33
  v_exp_f32 v162, v34
  v_mfma_f32_32x32x16_bf16 v[64:79], v[212:215], v[196:199], v[64:79]
  v_exp_f32 v163, v35
  v_exp_f32 v164, v36
  v_exp_f32 v165, v37
  v_exp_f32 v166, v38
  v_exp_f32 v167, v39
  v_exp_f32 v168, v40
  v_mfma_f32_32x32x16_bf16 v[80:95], v[212:215], v[204:207], v[80:95]
  v_exp_f32 v169, v41
  v_exp_f32 v170, v42
  s_waitcnt lgkmcnt(2)
  v_exp_f32 v171, v43
  v_exp_f32 v172, v44
  v_mfma_f32_32x32x16_bf16 v[0:15], v[96:99], v[112:115], 0
  v_exp_f32 v173, v45
  buffer_load_dwordx4 v224, s[32:35], s4 offen offset:0 lds
  v_exp_f32 v174, v46
  buffer_load_dwordx4 v225, s[32:35], s5 offen offset:1024 lds
  v_exp_f32 v175, v47
  buffer_load_dwordx4 v226, s[32:35], s6 offen offset:2048 lds
  v_exp_f32 v176, v48
  buffer_load_dwordx4 v227, s[32:35], s7 offen offset:3072 lds
  v_exp_f32 v177, v49
  v_exp_f32 v178, v50
  v_exp_f32 v179, v51
  v_mfma_f32_32x32x16_bf16 v[16:31], v[96:99], v[120:123], 0
  v_exp_f32 v180, v52
  v_exp_f32 v181, v53
  v_exp_f32 v182, v54
  v_exp_f32 v183, v55
  v_exp_f32 v184, v56
  v_exp_f32 v185, v57
  v_exp_f32 v186, v58
  v_mfma_f32_32x32x16_bf16 v[0:15], v[100:103], v[116:119], v[0:15]
  v_exp_f32 v187, v59
  v_exp_f32 v188, v60
  v_exp_f32 v189, v61
  v_exp_f32 v190, v62
  s_waitcnt vmcnt(8) lgkmcnt(0)
  v_exp_f32 v191, v63
  v_add_f32 v160, 1.0, v160
  v_add_f32 v161, 1.0, v161
  v_pk_add_f32 v[228:229], v[228:229], v[240:241] neg_lo:[0,1] neg_hi:[0,1]
  v_add_f32 v162, 1.0, v162
  v_add_f32 v163, 1.0, v163
  v_sub_f32 v230, v230, v242
  v_add_f32 v164, 1.0, v164
  v_add_f32 v165, 1.0, v165
  v_add_u32 v250, v235, v243
  v_add_f32 v166, 1.0, v166
  v_add_f32 v167, 1.0, v167
  v_mul_f32 v253, v228, v228
  v_add_f32 v168, 1.0, v168
  v_add_f32 v169, 1.0, v169
  v_fmac_f32 v253, v229, v229
  v_add_f32 v170, 1.0, v170
  v_add_f32 v171, 1.0, v171
  v_fmac_f32 v253, v230, v230
  v_add_f32 v172, 1.0, v172
  v_add_f32 v173, 1.0, v173
  v_add_f32 v174, 1.0, v174
  v_add_f32 v175, 1.0, v175
  v_add_f32 v176, 1.0, v176
  v_add_f32 v177, 1.0, v177
  v_add_f32 v178, 1.0, v178
  v_add_f32 v179, 1.0, v179
  v_add_f32 v180, 1.0, v180
  v_add_f32 v181, 1.0, v181
  v_add_f32 v182, 1.0, v182
  v_add_f32 v183, 1.0, v183
  v_add_f32 v184, 1.0, v184
  v_add_f32 v185, 1.0, v185
  v_add_f32 v186, 1.0, v186
  v_add_f32 v187, 1.0, v187
  v_add_f32 v188, 1.0, v188
  v_add_f32 v189, 1.0, v189
  v_add_f32 v190, 1.0, v190
  v_add_f32 v191, 1.0, v191
  v_rcp_f32 v160, v160
  v_cvt_pk_bf16_f32 v130, v253, v253
  v_cvt_pk_bf16_f32 v244, 1.0, v228
  v_cvt_pk_bf16_f32 v245, v229, v230
  v_rcp_f32 v161, v161
  v_mfma_f32_32x32x16_bf16 v[16:31], v[100:103], v[124:127], v[16:31]
  v_rcp_f32 v162, v162
  v_permlane32_swap_b32 v128, v132
  v_permlane32_swap_b32 v129, v133
  v_permlane32_swap_b32 v130, v134
  v_rcp_f32 v163, v163
  ds_read_b128 v[224:227], v248 offset:640
  v_rcp_f32 v164, v164
  ds_write_b64 v250, v[244:245]
  v_rcp_f32 v165, v165
  v_rcp_f32 v166, v166
  ds_read_b64_tr_b16 v[208:209], v236 offset:0
  v_rcp_f32 v167, v167
  ds_read_b64_tr_b16 v[210:211], v236 offset:384
  v_rcp_f32 v168, v168
  ds_read_b64_tr_b16 v[212:213], v236 offset:768
  v_rcp_f32 v169, v169
  ds_read_b64_tr_b16 v[214:215], v236 offset:1152
  v_rcp_f32 v170, v170
  v_mfma_f32_32x32x16_bf16 v[0:15], v[128:131], v[104:107], v[0:15]
  v_rcp_f32 v171, v171
  v_rcp_f32 v172, v172
  ds_read2st64_b32 v[228:229], v249 offset0:2 offset1:10
  v_rcp_f32 v173, v173
  v_rcp_f32 v174, v174
  v_rcp_f32 v175, v175
  v_rcp_f32 v176, v176
  v_rcp_f32 v177, v177
  v_rcp_f32 v178, v178
  v_rcp_f32 v179, v179
  v_mfma_f32_32x32x16_bf16 v[16:31], v[128:131], v[108:111], v[16:31]
  v_rcp_f32 v180, v180
  v_rcp_f32 v181, v181
  v_rcp_f32 v182, v182
  v_rcp_f32 v183, v183
  v_rcp_f32 v184, v184
  v_rcp_f32 v185, v185
  v_rcp_f32 v186, v186
  v_rcp_f32 v187, v187
  v_rcp_f32 v188, v188
  s_sub_u32 s31, s31, 1
  v_rcp_f32 v189, v189
  v_rcp_f32 v190, v190
  s_waitcnt lgkmcnt(0)
  v_rcp_f32 v191, v191
  v_mul_f32 v160, v160, v32
  v_mul_f32 v161, v161, v33
  v_pk_add_f32 v[224:225], v[224:225], v[232:233] op_sel_hi:[1,0]
  v_mul_f32 v162, v162, v34
  v_pk_add_f32 v[226:227], v[226:227], v[232:233] op_sel_hi:[1,0]
  v_mul_f32 v163, v163, v35
  v_or_b32_sdwa v243, v251, v229 dst_sel:DWORD dst_unused:UNUSED_PAD src0_sel:DWORD src1_sel:BYTE_3
  v_mul_f32 v164, v164, v36
  v_lshrrev_b32 v228, 3, v228
  v_mul_f32 v165, v165, v37
  v_and_b32 v229, 0xffffff, v229
  v_mul_f32 v166, v166, v38
  v_pk_add_f32 v[248:249], v[248:249], s[52:53]
  v_mul_f32 v167, v167, v39
  v_mul_f32 v168, v168, v40
  v_mul_f32 v169, v169, v41
  v_mul_f32 v170, v170, v42
  v_mul_f32 v171, v171, v43
  v_mul_f32 v172, v172, v44
  v_mul_f32 v173, v173, v45
  v_mul_f32 v174, v174, v46
  v_mul_f32 v175, v175, v47
  v_mul_f32 v176, v176, v48
  v_mul_f32 v177, v177, v49
  v_mul_f32 v178, v178, v50
  v_mul_f32 v179, v179, v51
  v_mul_f32 v180, v180, v52
  v_mul_f32 v181, v181, v53
  v_mul_f32 v182, v182, v54
  v_mul_f32 v183, v183, v55
  v_mul_f32 v184, v184, v56
  v_mul_f32 v185, v185, v57
  v_mul_f32 v186, v186, v58
  v_mul_f32 v187, v187, v59
  v_mul_f32 v188, v188, v60
  v_mul_f32 v189, v189, v61
  v_mul_f32 v190, v190, v62
  v_mul_f32 v191, v191, v63
  v_cvt_pk_bf16_f32 v192, v160, v161
  v_cvt_pk_bf16_f32 v193, v162, v163
  v_cvt_pk_bf16_f32 v194, v164, v165
  v_cvt_pk_bf16_f32 v195, v166, v167
  v_cvt_pk_bf16_f32 v196, v168, v169
  v_cvt_pk_bf16_f32 v197, v170, v171
  v_cvt_pk_bf16_f32 v198, v172, v173
  v_cvt_pk_bf16_f32 v199, v174, v175
  v_cvt_pk_bf16_f32 v200, v176, v177
  v_cvt_pk_bf16_f32 v201, v178, v179
  v_cvt_pk_bf16_f32 v202, v180, v181
  v_cvt_pk_bf16_f32 v203, v182, v183
  v_cvt_pk_bf16_f32 v204, v184, v185
  v_cvt_pk_bf16_f32 v205, v186, v187
  v_cvt_pk_bf16_f32 v206, v188, v189
  v_cvt_pk_bf16_f32 v207, v190, v191
  s_cbranch_scc0 K2_LOOPS
K2_TAIL0S:
  s_lshl_b32 s60, s30, 5
  s_sub_u32 s60, s21, s60
  s_add_u32 s60, s60, 32
  ds_write_b64 v250, v[246:247]
  s_nop 0
  s_nop 0
  s_nop 0
  s_nop 0
  v_exp_f32 v160, v0
  v_mfma_f32_32x32x16_bf16 v[64:79], v[216:219], v[192:195], v[64:79]
  v_exp_f32 v161, v1
  v_exp_f32 v162, v2
  v_mfma_f32_32x32x16_bf16 v[80:95], v[216:219], v[200:203], v[80:95]
  v_exp_f32 v163, v3
  v_exp_f32 v176, v16
  v_mfma_f32_32x32x16_bf16 v[64:79], v[220:223], v[196:199], v[64:79]
  v_exp_f32 v177, v17
  v_exp_f32 v178, v18
  v_mfma_f32_32x32x16_bf16 v[80:95], v[220:223], v[204:207], v[80:95]
  v_exp_f32 v179, v19
  v_add_f32 v160, 1.0, v160
  v_add_f32 v161, 1.0, v161
  v_add_f32 v162, 1.0, v162
  v_add_f32 v163, 1.0, v163
  v_add_f32 v176, 1.0, v176
  v_add_f32 v177, 1.0, v177
  v_add_f32 v178, 1.0, v178
  v_add_f32 v179, 1.0, v179
  v_rcp_f32 v160, v160
  v_rcp_f32 v161, v161
  v_rcp_f32 v162, v162
  v_rcp_f32 v163, v163
  v_rcp_f32 v176, v176
  v_rcp_f32 v177, v177
  v_rcp_f32 v178, v178
  v_rcp_f32 v179, v179
  v_mul_f32 v160, v160, v0
  v_mul_f32 v161, v161, v1
  v_mul_f32 v162, v162, v2
  v_mul_f32 v163, v163, v3
  v_mul_f32 v176, v176, v16
  v_mul_f32 v177, v177, v17
  v_mul_f32 v178, v178, v18
  v_mul_f32 v179, v179, v19
  v_cvt_pk_bf16_f32 v192, v160, v161
  v_cvt_pk_bf16_f32 v193, v162, v163
  v_cvt_pk_bf16_f32 v200, v176, v177
  v_cvt_pk_bf16_f32 v201, v178, v179
  s_cmp_le_u32 s60, 8
  s_cbranch_scc1 K2_TEND_0S
  s_nop 0
  s_nop 0
  s_nop 0
  s_nop 0
  v_exp_f32 v164, v4
  v_exp_f32 v165, v5
  v_exp_f32 v166, v6
  v_exp_f32 v167, v7
  v_exp_f32 v180, v20
  v_exp_f32 v181, v21
  v_exp_f32 v182, v22
  v_exp_f32 v183, v23
  v_add_f32 v164, 1.0, v164
  v_add_f32 v165, 1.0, v165
  v_add_f32 v166, 1.0, v166
  v_add_f32 v167, 1.0, v167
  v_add_f32 v180, 1.0, v180
  v_add_f32 v181, 1.0, v181
  v_add_f32 v182, 1.0, v182
  v_add_f32 v183, 1.0, v183
  v_rcp_f32 v164, v164
  v_rcp_f32 v165, v165
  v_rcp_f32 v166, v166
  v_rcp_f32 v167, v167
  v_rcp_f32 v180, v180
  v_rcp_f32 v181, v181
  v_rcp_f32 v182, v182
  v_rcp_f32 v183, v183
  v_mul_f32 v164, v164, v4
  v_mul_f32 v165, v165, v5
  v_mul_f32 v166, v166, v6
  v_mul_f32 v167, v167, v7
  v_mul_f32 v180, v180, v20
  v_mul_f32 v181, v181, v21
  v_mul_f32 v182, v182, v22
  v_mul_f32 v183, v183, v23
  v_cvt_pk_bf16_f32 v194, v164, v165
  v_cvt_pk_bf16_f32 v195, v166, v167
  v_cvt_pk_bf16_f32 v202, v180, v181
  v_cvt_pk_bf16_f32 v203, v182, v183
  s_cmp_le_u32 s60, 16
  s_cbranch_scc1 K2_TEND_0S
  s_nop 0
  s_nop 0
  s_nop 0
  s_nop 0
  v_exp_f32 v168, v8
  v_exp_f32 v169, v9
  v_exp_f32 v170, v10
  v_exp_f32 v171, v11
  v_exp_f32 v184, v24
  v_exp_f32 v185, v25
  v_exp_f32 v186, v26
  v_exp_f32 v187, v27
  v_add_f32 v168, 1.0, v168
  v_add_f32 v169, 1.0, v169
  v_add_f32 v170, 1.0, v170
  v_add_f32 v171, 1.0, v171
  v_add_f32 v184, 1.0, v184
  v_add_f32 v185, 1.0, v185
  v_add_f32 v186, 1.0, v186
  v_add_f32 v187, 1.0, v187
  v_rcp_f32 v168, v168
  v_rcp_f32 v169, v169
  v_rcp_f32 v170, v170
  v_rcp_f32 v171, v171
  v_rcp_f32 v184, v184
  v_rcp_f32 v185, v185
  v_rcp_f32 v186, v186
  v_rcp_f32 v187, v187
  v_mul_f32 v168, v168, v8
  v_mul_f32 v169, v169, v9
  v_mul_f32 v170, v170, v10
  v_mul_f32 v171, v171, v11
  v_mul_f32 v184, v184, v24
  v_mul_f32 v185, v185, v25
  v_mul_f32 v186, v186, v26
  v_mul_f32 v187, v187, v27
  v_cvt_pk_bf16_f32 v196, v168, v169
  v_cvt_pk_bf16_f32 v197, v170, v171
  v_cvt_pk_bf16_f32 v204, v184, v185
  v_cvt_pk_bf16_f32 v205, v186, v187
  s_cmp_le_u32 s60, 24
  s_cbranch_scc1 K2_TEND_0S
  s_nop 0
  s_nop 0
  s_nop 0
  s_nop 0
  v_exp_f32 v172, v12
  v_exp_f32 v173, v13
  v_exp_f32 v174, v14
  v_exp_f32 v175, v15
  v_exp_f32 v188, v28
  v_exp_f32 v189, v29
  v_exp_f32 v190, v30
  v_exp_f32 v191, v31
  v_add_f32 v172, 1.0, v172
  v_add_f32 v173, 1.0, v173
  v_add_f32 v174, 1.0, v174
  v_add_f32 v175, 1.0, v175
  v_add_f32 v188, 1.0, v188
  v_add_f32 v189, 1.0, v189
  v_add_f32 v190, 1.0, v190
  v_add_f32 v191, 1.0, v191
  v_rcp_f32 v172, v172
  v_rcp_f32 v173, v173
  v_rcp_f32 v174, v174
  v_rcp_f32 v175, v175
  v_rcp_f32 v188, v188
  v_rcp_f32 v189, v189
  v_rcp_f32 v190, v190
  v_rcp_f32 v191, v191
  v_mul_f32 v172, v172, v12
  v_mul_f32 v173, v173, v13
  v_mul_f32 v174, v174, v14
  v_mul_f32 v175, v175, v15
  v_mul_f32 v188, v188, v28
  v_mul_f32 v189, v189, v29
  v_mul_f32 v190, v190, v30
  v_mul_f32 v191, v191, v31
  v_cvt_pk_bf16_f32 v198, v172, v173
  v_cvt_pk_bf16_f32 v199, v174, v175
  v_cvt_pk_bf16_f32 v206, v188, v189
  v_cvt_pk_bf16_f32 v207, v190, v191
K2_TEND_0S:
  s_nop 1
  v_mfma_f32_32x32x16_bf16 v[64:79], v[208:211], v[192:195], v[64:79]
  v_mfma_f32_32x32x16_bf16 v[80:95], v[208:211], v[200:203], v[80:95]
  v_mfma_f32_32x32x16_bf16 v[64:79], v[212:215], v[196:199], v[64:79]
  v_mfma_f32_32x32x16_bf16 v[80:95], v[212:215], v[204:207], v[80:95]
  s_branch K2_WEND
K2_TAIL1S:
  s_lshl_b32 s60, s30, 5
  s_sub_u32 s60, s21, s60
  s_add_u32 s60, s60, 32
  s_nop 0
  s_nop 0
  s_nop 0
  s_nop 0
  v_exp_f32 v160, v32
  v_mfma_f32_32x32x16_bf16 v[64:79], v[208:211], v[192:195], v[64:79]
  v_exp_f32 v161, v33
  v_exp_f32 v162, v34
  v_mfma_f32_32x32x16_bf16 v[80:95], v[208:211], v[200:203], v[80:95]
  v_exp_f32 v163, v35
  v_exp_f32 v176, v48
  v_mfma_f32_32x32x16_bf16 v[64:79], v[212:215], v[196:199], v[64:79]
  v_exp_f32 v177, v49
  v_exp_f32 v178, v50
  v_mfma_f32_32x32x16_bf16 v[80:95], v[212:215], v[204:207], v[80:95]
  v_exp_f32 v179, v51
  v_add_f32 v160, 1.0, v160
  v_add_f32 v161, 1.0, v161
  v_add_f32 v162, 1.0, v162
  v_add_f32 v163, 1.0, v163
  v_add_f32 v176, 1.0, v176
  v_add_f32 v177, 1.0, v177
  v_add_f32 v178, 1.0, v178
  v_add_f32 v179, 1.0, v179
  v_rcp_f32 v160, v160
  v_rcp_f32 v161, v161
  v_rcp_f32 v162, v162
  v_rcp_f32 v163, v163
  v_rcp_f32 v176, v176
  v_rcp_f32 v177, v177
  v_rcp_f32 v178, v178
  v_rcp_f32 v179, v179
  v_mul_f32 v160, v160, v32
  v_mul_f32 v161, v161, v33
  v_mul_f32 v162, v162, v34
  v_mul_f32 v163, v163, v35
  v_mul_f32 v176, v176, v48
  v_mul_f32 v177, v177, v49
  v_mul_f32 v178, v178, v50
  v_mul_f32 v179, v179, v51
  v_cvt_pk_bf16_f32 v192, v160, v161
  v_cvt_pk_bf16_f32 v193, v162, v163
  v_cvt_pk_bf16_f32 v200, v176, v177
  v_cvt_pk_bf16_f32 v201, v178, v179
  s_cmp_le_u32 s60, 8
  s_cbranch_scc1 K2_TEND_1S
  s_nop 0
  s_nop 0
  s_nop 0
  s_nop 0
  v_exp_f32 v164, v36
  v_exp_f32 v165, v37
  v_exp_f32 v166, v38
  v_exp_f32 v167, v39
  v_exp_f32 v180, v52
  v_exp_f32 v181, v53
  v_exp_f32 v182, v54
  v_exp_f32 v183, v55
  v_add_f32 v164, 1.0, v164
  v_add_f32 v165, 1.0, v165
  v_add_f32 v166, 1.0, v166
  v_add_f32 v167, 1.0, v167
  v_add_f32 v180, 1.0, v180
  v_add_f32 v181, 1.0, v181
  v_add_f32 v182, 1.0, v182
  v_add_f32 v183, 1.0, v183
  v_rcp_f32 v164, v164
  v_rcp_f32 v165, v165
  v_rcp_f32 v166, v166
  v_rcp_f32 v167, v167
  v_rcp_f32 v180, v180
  v_rcp_f32 v181, v181
  v_rcp_f32 v182, v182
  v_rcp_f32 v183, v183
  v_mul_f32 v164, v164, v36
  v_mul_f32 v165, v165, v37
  v_mul_f32 v166, v166, v38
  v_mul_f32 v167, v167, v39
  v_mul_f32 v180, v180, v52
  v_mul_f32 v181, v181, v53
  v_mul_f32 v182, v182, v54
  v_mul_f32 v183, v183, v55
  v_cvt_pk_bf16_f32 v194, v164, v165
  v_cvt_pk_bf16_f32 v195, v166, v167
  v_cvt_pk_bf16_f32 v202, v180, v181
  v_cvt_pk_bf16_f32 v203, v182, v183
  s_cmp_le_u32 s60, 16
  s_cbranch_scc1 K2_TEND_1S
  s_nop 0
  s_nop 0
  s_nop 0
  s_nop 0
  v_exp_f32 v168, v40
  v_exp_f32 v169, v41
  v_exp_f32 v170, v42
  v_exp_f32 v171, v43
  v_exp_f32 v184, v56
  v_exp_f32 v185, v57
  v_exp_f32 v186, v58
  v_exp_f32 v187, v59
  v_add_f32 v168, 1.0, v168
  v_add_f32 v169, 1.0, v169
  v_add_f32 v170, 1.0, v170
  v_add_f32 v171, 1.0, v171
  v_add_f32 v184, 1.0, v184
  v_add_f32 v185, 1.0, v185
  v_add_f32 v186, 1.0, v186
  v_add_f32 v187, 1.0, v187
  v_rcp_f32 v168, v168
  v_rcp_f32 v169, v169
  v_rcp_f32 v170, v170
  v_rcp_f32 v171, v171
  v_rcp_f32 v184, v184
  v_rcp_f32 v185, v185
  v_rcp_f32 v186, v186
  v_rcp_f32 v187, v187
  v_mul_f32 v168, v168, v40
  v_mul_f32 v169, v169, v41
  v_mul_f32 v170, v170, v42
  v_mul_f32 v171, v171, v43
  v_mul_f32 v184, v184, v56
  v_mul_f32 v185, v185, v57
  v_mul_f32 v186, v186, v58
  v_mul_f32 v187, v187, v59
  v_cvt_pk_bf16_f32 v196, v168, v169
  v_cvt_pk_bf16_f32 v197, v170, v171
  v_cvt_pk_bf16_f32 v204, v184, v185
  v_cvt_pk_bf16_f32 v205, v186, v187
  s_cmp_le_u32 s60, 24
  s_cbranch_scc1 K2_TEND_1S
  s_nop 0
  s_nop 0
  s_nop 0
  s_nop 0
  v_exp_f32 v172, v44
  v_exp_f32 v173, v45
  v_exp_f32 v174, v46
  v_exp_f32 v175, v47
  v_exp_f32 v188, v60
  v_exp_f32 v189, v61
  v_exp_f32 v190, v62
  v_exp_f32 v191, v63
  v_add_f32 v172, 1.0, v172
  v_add_f32 v173, 1.0, v173
  v_add_f32 v174, 1.0, v174
  v_add_f32 v175, 1.0, v175
  v_add_f32 v188, 1.0, v188
  v_add_f32 v189, 1.0, v189
  v_add_f32 v190, 1.0, v190
  v_add_f32 v191, 1.0, v191
  v_rcp_f32 v172, v172
  v_rcp_f32 v173, v173
  v_rcp_f32 v174, v174
  v_rcp_f32 v175, v175
  v_rcp_f32 v188, v188
  v_rcp_f32 v189, v189
  v_rcp_f32 v190, v190
  v_rcp_f32 v191, v191
  v_mul_f32 v172, v172, v44
  v_mul_f32 v173, v173, v45
  v_mul_f32 v174, v174, v46
  v_mul_f32 v175, v175, v47
  v_mul_f32 v188, v188, v60
  v_mul_f32 v189, v189, v61
  v_mul_f32 v190, v190, v62
  v_mul_f32 v191, v191, v63
  v_cvt_pk_bf16_f32 v198, v172, v173
  v_cvt_pk_bf16_f32 v199, v174, v175
  v_cvt_pk_bf16_f32 v206, v188, v189
  v_cvt_pk_bf16_f32 v207, v190, v191
K2_TEND_1S:
  s_nop 1
  v_mfma_f32_32x32x16_bf16 v[64:79], v[216:219], v[192:195], v[64:79]
  v_mfma_f32_32x32x16_bf16 v[80:95], v[216:219], v[200:203], v[80:95]
  v_mfma_f32_32x32x16_bf16 v[64:79], v[220:223], v[196:199], v[64:79]
  v_mfma_f32_32x32x16_bf16 v[80:95], v[220:223], v[204:207], v[80:95]
  s_branch K2_WEND
K2_SHI:
  v_lshrrev_b32 v8, s62, v1
  v_lshrrev_b32 v10, s62, v3
  v_lshrrev_b32 v12, s62, v5
  v_lshrrev_b32 v14, s62, v7
  s_branch K2_SHR
K2_PAD0:
  s_sub_u32 s60, 0, s21
  s_and_b32 s60, s60, 63
  s_lshl_b32 s61, s21, 2
  v_add_u32 v0, s61, v249
  ds_write2st64_b32 v0, v246, v246 offset0:0 offset1:8
  s_bfm_b64 exec, s60, 0
  ds_write2st64_b32 v0, v246, v246 offset0:1 offset1:9
  s_mov_b64 exec, -1
  s_branch K2_PAD0R
K2_NOH1X:
  s_waitcnt lgkmcnt(0)
  s_branch K2_NOH1
K2_FLAG:
  v_cmp_gt_i32 s[64:65], 0, v1
  s_nop 1
  v_cndmask_b32 v24, v24, 0, s[64:65]
  v_cmp_gt_i32 s[66:67], 0, v3
  s_nop 1
  v_cndmask_b32 v25, v25, 0, s[66:67]
  v_cmp_gt_i32 s[68:69], 0, v5
  s_nop 1
  v_cndmask_b32 v26, v26, 0, s[68:69]
  v_cmp_gt_i32 s[70:71], 0, v7
  s_nop 1
  v_cndmask_b32 v27, v27, 0, s[70:71]
  s_branch K2_FLAGRET
K2_SAFE:
  s_mov_b64 exec, -1
  s_mov_b64 s[36:37], 0
  s_mov_b32 s22, 0
  s_mov_b32 s29, 0
  v_lshlrev_b32 v20, 4, v252
  s_mov_b64 s[64:65], 0
  s_mov_b64 s[66:67], 0
  s_mov_b64 s[68:69], 0
  s_mov_b64 s[70:71], 0
  s_nop 7
  s_nop 7
  v_and_b32 v24, 31, v252
  v_lshrrev_b32 v25, 5, v252
  v_mul_u32_u24 v24, 12, v24
  v_mad_u32_u24 v24, v25, s25, v24
  buffer_load_dwordx3 v[104:106], v24, s[32:35], s38 offen offset:0
  buffer_load_dwordx3 v[108:110], v24, s[32:35], s38 offen offset:384
  buffer_load_dwordx4 v[96:99], v20, s[32:35], s38 offen offset:1024
  buffer_load_dwordx4 v[100:103], v20, s[32:35], s38 offen offset:2048
  v_mov_b32 v107, 0
  v_mov_b32 v111, 0
  v_mov_b32 v131, 0
  v_mov_b32 v136, 0
  v_mov_b32 v137, 0
  v_mov_b32 v138, 0
  v_mov_b32 v139, 0
  s_nop 1
  v_mfma_f32_32x32x16_bf16 v[64:79], v[136:139], v[136:139], 0
  v_mfma_f32_32x32x16_bf16 v[80:95], v[136:139], v[136:139], 0
  v_mfma_f32_32x32x16_bf16 v[192:207], v[136:139], v[136:139], 0
K2_LIST:
  v_lshlrev_b32 v20, 4, v252
  v_lshlrev_b32 v21, 5, v252
  s_mul_i32 s62, s13, 6
  s_cmp_ge_u32 s13, 6
  s_cselect_b32 s60, 4, 6
  s_sub_u32 s62, s62, s60
  s_cmp_eq_u32 s13, 5
  s_cselect_b32 s10, 8, 6
  s_cmp_eq_u32 s13, 0
  s_cselect_b32 s62, 0, s62
  s_cselect_b32 s10, 0, s10
  s_cselect_b32 s9, 0, 63
  buffer_load_dwordx4 v[0:3], v21, s[32:35], s19 offen offset:0
  buffer_load_dwordx4 v[4:7], v21, s[32:35], s19 offen offset:16
  v_mov_b32 v216, 0
  v_mov_b32 v217, 0
  v_mov_b32 v218, 0
  v_mov_b32 v219, 0
  v_mov_b32 v220, 0
  v_mov_b32 v221, 0
  v_mov_b32 v222, 0
  v_mov_b32 v223, 0
  v_mov_b32 v136, 0
  v_mov_b32 v137, 0
  v_mov_b32 v138, 0
  v_mov_b32 v139, 0
  v_lshlrev_b32 v126, 5, v252
  v_add_u32 v125, s0, v20
  v_lshlrev_b32 v112, 8, v252
  v_add_u32 v112, 2048, v112
  v_mul_u32_u24 v116, 80000, v252
  v_add_u32 v120, s1, v126
  ds_write_b128 v125, v[136:139]
  ds_write_b128 v125, v[136:139] offset:1024
  v_add_u32 v113, 64, v112
  v_add_u32 v117, 20000, v116
  v_add_u32 v121, 8, v120
  v_add_u32 v114, 128, v112
  v_add_u32 v118, 40000, v116
  v_add_u32 v122, 16, v120
  v_add_u32 v115, 192, v112
  v_add_u32 v119, 60000, v116
  v_add_u32 v123, 24, v120
  s_waitcnt vmcnt(0)
  s_branch K2_LIST1
K2_WEND:
  s_setprio 0
  s_waitcnt vmcnt(0) lgkmcnt(0)
  s_cmp_lg_u32 s22, 0
  s_cbranch_scc1 K2_BRET
  s_add_u32 s29, s29, 448
  s_cmp_lt_u32 s29, s28
  s_cbranch_scc1 K2_LIST
  s_mov_b32 s22, 1
  s_mov_b32 s23, 0
  s_mov_b32 s11, 0
K2_BRET:
  s_mov_b32 s18, 0
  s_cmp_eq_u32 s22, 2
  s_cbranch_scc1 K2_FIN
K2_BLOOP:
  s_cmp_gt_i32 s11, 0
  s_cbranch_scc1 K2_BSTEP
  s_ff1_i32_b64 s16, s[64:65]
  s_cmp_eq_i32 s16, -1
  s_cbranch_scc1 K2_BN0
  s_bitset0_b64 s[64:65], s16
  s_lshl_b32 s16, s16, 2
  s_add_u32 s16, s16, 0
  s_branch K2_BNEW
K2_BN0:
  s_ff1_i32_b64 s16, s[66:67]
  s_cmp_eq_i32 s16, -1
  s_cbranch_scc1 K2_BN1
  s_bitset0_b64 s[66:67], s16
  s_lshl_b32 s16, s16, 2
  s_add_u32 s16, s16, 1
  s_branch K2_BNEW
K2_BN1:
  s_ff1_i32_b64 s16, s[68:69]
  s_cmp_eq_i32 s16, -1
  s_cbranch_scc1 K2_BN2
  s_bitset0_b64 s[68:69], s16
  s_lshl_b32 s16, s16, 2
  s_add_u32 s16, s16, 2
  s_branch K2_BNEW
K2_BN2:
  s_ff1_i32_b64 s16, s[70:71]
  s_cmp_eq_i32 s16, -1
  s_cbranch_scc1 K2_BN3
  s_bitset0_b64 s[70:71], s16
  s_lshl_b32 s16, s16, 2
  s_add_u32 s16, s16, 3
  s_branch K2_BNEW
K2_BN3:
  s_mov_b32 s22, 2
  s_branch K2_BRUN
K2_BNEW:
  s_lshl_b32 s60, s16, 3
  v_mov_b32 v0, s60
  buffer_load_dwordx2 v[0:1], v0, s[32:35], s19 offen
  s_waitcnt vmcnt(0)
  v_readfirstlane_b32 s11, v0
  v_readfirstlane_b32 s60, v1
  s_bfe_u32 s60, s60, 786450
  s_mul_i32 s12, s16, 2500
  s_add_u32 s12, s12, s60
  s_lshl_b32 s12, s12, 2
  s_add_u32 s12, s12, 11534336
  s_mul_i32 s16, s16, 20000
K2_BSTEP:
  v_lshlrev_b32 v0, 2, v252
  buffer_load_dword v1, v0, s[32:35], s12 offen
  v_cmp_gt_i32 s[2:3], s11, v252
  s_waitcnt vmcnt(0)
  v_bfe_u32 v2, v1, 17, 3
  v_cmp_eq_u32 vcc, s13, v2
  s_and_b64 vcc, vcc, s[2:3]
  v_bfe_u32 v2, v1, 3, 14
  v_lshlrev_b32 v2, 7, v2
  v_lshrrev_b32 v3, 20, v1
  v_lshl_add_u32 v3, v3, 3, s16
  v_and_b32 v4, 7, v1
  v_lshl_add_u32 v3, v4, 28, v3
  v_mbcnt_lo_u32_b32 v12, vcc_lo, 0
  v_mbcnt_hi_u32_b32 v12, vcc_hi, v12
  v_add_u32 v12, s18, v12
  v_lshl_add_u32 v12, v12, 2, s27
  s_bcnt1_i32_b64 s61, vcc
  s_add_u32 s18, s18, s61
  s_mov_b64 exec, vcc
  ds_write2st64_b32 v12, v2, v3 offset0:0 offset1:8
  s_mov_b64 exec, -1
  s_add_u32 s12, s12, 256
  s_sub_i32 s11, s11, 64
  s_cmp_le_u32 s18, 384
  s_cbranch_scc1 K2_BLOOP
K2_BRUN:
  s_mov_b32 s21, s18
  v_mov_b32 v216, 0
  v_mov_b32 v217, 0
  v_mov_b32 v218, 0
  v_mov_b32 v219, 0
  v_mov_b32 v220, 0
  v_mov_b32 v221, 0
  v_mov_b32 v222, 0
  v_mov_b32 v223, 0
  v_lshlrev_b32 v249, 2, v252
  v_add_u32 v249, s27, v249
  v_lshrrev_b32 v248, 3, v252
  v_lshl_add_u32 v248, v248, 4, s27
  s_branch K2_RUN
K2_FIN:
  v_lshlrev_b32 v20, 4, v252
  s_sub_u32 s60, s27, s63
  buffer_load_dwordx4 v[48:51], v20, s[32:35], s39 offen offset:2048
  s_cmp_eq_u32 s20, 0
  s_cbranch_scc1 K2_FIN2
  v_add_u32 v233, s27, v233
  v_add_u32 v234, s27, v234
  v_add_u32 v235, s60, v235
  v_add_u32 v236, s27, v236
  v_add_u32 v237, s27, v237
  v_add_u32 v238, s27, v238
  v_add_u32 v239, s63, v239
  s_mov_b32 s50, 1340000
  s_mov_b32 s51, 0x20000
  s_movk_i32 s41, 0x207
  s_movk_i32 s52, 256
  s_movk_i32 s53, 256
  s_mov_b32 s20, 0
K2_FIN2:
  s_waitcnt vmcnt(0)
  s_nop 7
  s_nop 7
  v_lshlrev_b32 v46, 4, v252
  v_add_u32 v44, s27, v49
  v_add_u32 v45, s27, v50
  ds_read_b128 v[32:35], v238 offset:15392
  ds_read_b128 v[36:39], v238 offset:15456
  ds_read_b64 v[40:41], v44 offset:15392
  ds_read_b64 v[42:43], v45 offset:15904
  ds_read_b128 v[96:99], v46 offset:18432
  ds_read_b128 v[100:103], v46 offset:19456
  ds_read_b128 v[104:107], v46 offset:20480
  ds_read_b128 v[108:111], v46 offset:21504
  ds_read_b128 v[112:115], v46 offset:22528
  ds_read_b128 v[116:119], v46 offset:23552
  ds_read_b128 v[120:123], v46 offset:24576
  ds_read_b128 v[124:127], v46 offset:25600
  ds_read_b128 v[128:131], v46 offset:26624
  ds_read_b128 v[132:135], v46 offset:27648
  ds_read_b128 v[136:139], v46 offset:28672
  ds_read_b128 v[140:143], v46 offset:29696
  ds_read_b128 v[144:147], v46 offset:30720
  ds_read_b128 v[148:151], v46 offset:31744
  ds_read_b128 v[152:155], v46 offset:32768
  ds_read_b128 v[156:159], v46 offset:33792
  s_branch K2_EPI
K2_END:
  s_endpgm
.section .rodata,"a"
.p2align 6
.amdhsa_kernel sort_kernel
  .amdhsa_next_free_vgpr 148
  .amdhsa_next_free_sgpr 64
  .amdhsa_accum_offset 148
  .amdhsa_group_segment_fixed_size 0
  .amdhsa_kernarg_size 88
  .amdhsa_user_sgpr_count 2
  .amdhsa_user_sgpr_kernarg_segment_ptr 1
  .amdhsa_system_sgpr_workgroup_id_x 1
  .amdhsa_float_denorm_mode_32 3
.end_amdhsa_kernel
.p2align 6
.amdhsa_kernel main_kernel
  .amdhsa_next_free_vgpr 256
  .amdhsa_next_free_sgpr 72
  .amdhsa_accum_offset 256
  .amdhsa_group_segment_fixed_size 0
  .amdhsa_kernarg_size 88
  .amdhsa_user_sgpr_count 2
  .amdhsa_user_sgpr_kernarg_segment_ptr 1
  .amdhsa_system_sgpr_workgroup_id_x 1
  .amdhsa_float_denorm_mode_32 3
.end_amdhsa_kernel
```
